```python
import torch

def _softmax(x, axis=-1):
    return torch.softmax(x, dim=axis)

def _gelu(x):
    return torch.nn.functional.gelu(x, approximate='tanh')

def _silu(x):
    return torch.nn.functional.silu(x)

def _sigmoid(x):
    return torch.sigmoid(x)

def _layernorm(x, axis=-1, eps=1e-05):
    m = x.mean(dim=axis, keepdim=True)
    v = x.var(dim=axis, keepdim=True, unbiased=False)
    return (x - m) / torch.sqrt(v + eps)

def _scatter_add(tgt, idx, src, axis=0):
    return tgt.clone().index_add_(axis, idx, src)

def _segment_sum(src, seg, n):
    out = torch.zeros((n,) + src.shape[1:], dtype=src.dtype)
    return out.index_add_(0, seg, src)

def _pad(x, pw):
    flat = tuple((v for pair in reversed(pw) for v in pair))
    return torch.nn.functional.pad(x, flat)
kernel_name = 'standalone__molecular_angular_painn__graph'

def setup_inputs():

    _w = lambda a: (lambda t: t.to(torch.bfloat16) if t.is_floating_point() else t)(torch.as_tensor(a))
    N, deg, D = (12500, 32, 128)
    n_rbf = max(16, 4)
    E = N * deg
    cutoff = 5.0
    freqs = (torch.arange(1, n_rbf + 1) * torch.pi / cutoff).to(float)
    return {'sv': _w((lambda *s: torch.randn(*s, dtype=torch.bfloat16) * 0.4)(N, 4, D) * 0.3), 'pos': _w((lambda *s: torch.randn(*s, dtype=torch.bfloat16) * 1.6)(N, 3) * 1.2), 'src': _w((lambda lo, hi, *s: torch.randint(lo, hi, s))(0, N, E).to(torch.int64)), 'dst': _w((lambda lo, hi, *s: torch.randint(lo, hi, s))(0, N, E).to(torch.int64)), 'freqs': _w(freqs), 'w_phi1': _w((lambda *s: torch.randn(*s, dtype=torch.bfloat16) * 3.2)(D, D) / D ** 0.5), 'w_phi2': _w((lambda *s: torch.randn(*s, dtype=torch.bfloat16) * 1.6)(D, 3 * D) / D ** 0.5), 'w_rbf': _w((lambda *s: torch.randn(*s, dtype=torch.bfloat16) * 1.6)(n_rbf, 3 * D) / n_rbf ** 0.5)}

def reference(sv, pos, src, dst, freqs, w_phi1, w_phi2, w_rbf):
    N, _, D = sv.shape
    E = src.shape[0]
    PI, cutoff = (3.141592653589793, 5.0)
    s, v = (sv[:, 0, :].clone(), sv[:, 1:, :].clone())
    r_vec = pos[src] - pos[dst]
    d = torch.sqrt((r_vec * r_vec).sum(-1) + 1e-08)
    r_hat = r_vec / d[:, None]
    rbf = torch.sin(d[:, None] * freqs[None, :]) / d[:, None]
    fcut = 0.5 * (torch.cos(PI * d / cutoff) + 1.0)
    fcut = torch.where(d < cutoff, fcut, 0.0 * d)
    Wf = rbf @ w_rbf * fcut[:, None]
    phi = (_silu(s @ w_phi1) @ w_phi2)[src]
    m = phi * Wf
    m_s, m_vv, m_vr = (m[:, :D].clone(), m[:, D:2 * D].clone(), m[:, 2 * D:].clone())
    ds = _segment_sum(m_s, dst, N)
    dv_e = m_vv[:, None, :] * v[src] + m_vr[:, None, :] * r_hat[:, :, None]
    dv = _segment_sum(dv_e.reshape(E, 3 * D), dst, N).reshape(N, 3, D)
    return sv + torch.concatenate([ds[:, None, :], dv], axis=1)
```

```asm
; @launch kernel=standalone__molecular_angular_painn__graph_kernel grid=(256,1,1) block=(1024,1,1) lds=163840
.amdgcn_target "amdgcn-amd-amdhsa--gfx950"
.text
.globl standalone__molecular_angular_painn__graph_kernel
.p2align 8
.type standalone__molecular_angular_painn__graph_kernel,@function
standalone__molecular_angular_painn__graph_kernel:
    s_cmp_ge_u32 s2, 256
    s_cbranch_scc1 M_END
    s_load_dwordx16 s[16:31], s[0:1], 0
    s_load_dwordx4 s[32:35], s[0:1], 72
    s_getpc_b64 s[10:11]
P_PC:
    v_lshlrev_b32 v126, 7, v0
    v_min_u32 v126, M_END-P_PC, v126
    global_load_dword v1, v126, s[10:11]
    s_and_b32 s92, s2, 3
    s_bfe_u32 s93, s2, 0x10002
    s_lshl_b32 s93, s93, 5
    s_lshr_b32 s4, s2, 3
    s_add_u32 s93, s93, s4
    s_lshr_b32 s4, s92, 1
    s_lshl1_add_u32 s4, s93, s4
    s_add_u32 s5, s4, 131
    s_cmp_lt_u32 s4, 120
    s_cselect_b32 s5, s4, s5
    s_add_u32 s4, s4, 120
    s_add_u32 s6, s92, s93
    s_bitcmp0_b32 s6, 0
    s_cselect_b32 s101, s5, s4
    s_lshl2_add_u32 s4, s93, s92
    s_sub_u32 s4, s4, 5
    s_cmp_eq_u32 s4, 243
    s_cselect_b32 s4, 255, s4
    s_cmp_ge_u32 s93, 62
    s_cselect_b32 s101, s4, s101
    v_readfirstlane_b32 s3, v0
    v_and_b32 v2, 63, v0
    v_lshlrev_b32 v3, 4, v0
    s_lshr_b32 s3, s3, 6
    s_waitcnt lgkmcnt(0)
    s_mov_b32 s36, s16
    s_and_b32 s37, s17, 0xffff
    s_mov_b32 s38, 12800000
    s_mov_b32 s39, 0x00020000
    s_mov_b32 s40, s18
    s_and_b32 s41, s19, 0xffff
    s_mov_b32 s42, 75000
    s_mov_b32 s43, 0x00020000
    s_mov_b32 s44, s20
    s_and_b32 s45, s21, 0xffff
    s_mov_b32 s46, 1600000
    s_mov_b32 s47, 0x00020000
    s_mov_b32 s48, s22
    s_and_b32 s49, s23, 0xffff
    s_mov_b32 s50, 1600000
    s_mov_b32 s51, 0x00020000
    s_mov_b32 s52, s24
    s_and_b32 s53, s25, 0xffff
    s_mov_b32 s54, 32
    s_mov_b32 s55, 0x00020000
    s_mov_b32 s56, s26
    s_and_b32 s57, s27, 0xffff
    s_mov_b32 s58, 32768
    s_mov_b32 s59, 0x00020000
    s_mov_b32 s60, s28
    s_and_b32 s61, s29, 0xffff
    s_mov_b32 s62, 98304
    s_mov_b32 s63, 0x00020000
    s_mov_b32 s64, s34
    s_and_b32 s65, s35, 0xffff
    s_mov_b32 s66, 31457280
    s_mov_b32 s67, 0x00020000
    s_mov_b32 s12, s32
    s_and_b32 s13, s33, 0xffff
    s_mov_b32 s14, 256
    s_mov_b32 s15, 0x00020000
    s_cmp_lt_u32 s101, 251
    s_cbranch_scc1 P_NOTL
    v_and_b32 v38, 15, v0
    v_lshlrev_b32 v38, 1, v38
    buffer_load_ushort v40, v38, s[52:55], 0 offen
    v_lshlrev_b32 v57, 8, v2
    v_mov_b32 v39, 0
    s_mov_b32 s5, 21078016
    s_mov_b64 exec, 0xffffffff
    s_cmp_lg_u32 s101, 255
    s_cbranch_scc1 P_NCLR
    s_cmp_lg_u32 s3, 0
    s_cbranch_scc1 P_NCLR
    buffer_store_dword v39, v57, s[64:67], s5 offen sc1
P_NCLR:
    s_mov_b64 exec, -1
    v_mov_b32 v44, -1
    v_mov_b32 v45, -1
    v_mov_b32 v46, -1
    v_mov_b32 v47, -1
    s_sub_u32 s4, s101, 251
    s_cmp_ge_u32 s4, 2
    s_cbranch_scc1 P_NMRK
    s_lshl_b32 s4, s4, 14
    s_add_u32 s4, s4, 21045248
    buffer_store_dwordx4 v[44:47], v3, s[64:67], s4 offen sc1
P_NMRK:
    s_sub_u32 s4, s101, 251
    s_mul_i32 s4, s4, 424
    s_add_u32 s6, s4, 424
    v_lshrrev_b32 v52, 4, v0
    v_add_u32 v52, s4, v52
    s_mov_b32 s5, 20975616
    s_mov_b32 s10, 0x55555555
    s_mov_b32 s11, s10
    s_waitcnt vmcnt(0)
    v_lshlrev_b32 v40, 16, v40
P_LUTL:
    v_add_u32 v53, 15486, v52
    v_add_u32 v54, 13472, v52
    v_cmp_gt_u32 vcc, 1056, v52
    v_cmp_eq_u32 s[8:9], 1, v52
    v_mov_b32 v55, 14546
    v_cndmask_b32 v53, v54, v53, vcc
    v_cndmask_b32 v53, v53, v55, s[8:9]
    v_lshlrev_b32 v53, 16, v53
    v_mul_f32 v54, 0x40490fdb, v53
    v_cvt_pk_bf16_f32 v54, v54, v54
    v_and_b32 v54, 0xffff0000, v54
    v_mul_f32 v54, 0x3e4ccccd, v54
    v_cvt_pk_bf16_f32 v54, v54, v54
    v_and_b32 v54, 0xffff0000, v54
    v_mul_f32 v54, 0.15915494, v54
    v_cos_f32 v54, v54
    v_rcp_f32 v55, v53
    v_cvt_pk_bf16_f32 v54, v54, v54
    v_and_b32 v54, 0xffff0000, v54
    v_add_f32 v54, 1.0, v54
    v_cvt_pk_bf16_f32 v54, v54, v54
    v_and_b32 v54, 0xffff0000, v54
    v_mul_f32 v54, 0.5, v54
    v_cvt_pk_bf16_f32 v54, v54, v54
    v_and_b32 v54, 0xffff0000, v54
    v_mul_f32 v39, v40, v53
    v_cvt_pk_bf16_f32 v39, v39, v39
    v_and_b32 v39, 0xffff0000, v39
    v_mul_f32 v39, 0.15915494, v39
    v_rndne_f32 v56, v39
    v_sub_f32 v39, v39, v56
    v_sin_f32 v39, v39
    v_cmp_ne_u32 s[8:9], 0, v52
    v_cmp_ne_u32 vcc, 1056, v52
    s_and_b64 s[8:9], s[8:9], vcc
    v_cvt_pk_bf16_f32 v39, v39, v39
    v_and_b32 v39, 0xffff0000, v39
    v_mul_f32 v39, v39, v55
    v_cvt_pk_bf16_f32 v39, v39, v39
    v_and_b32 v39, 0xffff0000, v39
    v_mul_f32 v39, v39, v54
    v_cndmask_b32 v39, 0, v39, s[8:9]
    v_lshl_add_u32 v57, v52, 5, v38
    v_cmp_gt_u32 vcc, s6, v52
    v_mov_b32_dpp v56, v39 quad_perm:[1,1,3,3] row_mask:0xf bank_mask:0xf
    v_cvt_pk_bf16_f32 v39, v39, v56
    s_and_b64 exec, vcc, s[10:11]
    s_cbranch_execz P_LUTS
    buffer_store_dword v39, v57, s[64:67], s5 offen sc1
P_LUTS:
    s_mov_b64 exec, -1
    v_add_u32 v52, 64, v52
    s_add_u32 s4, s4, 64
    s_cmp_lt_u32 s4, s6
    s_cbranch_scc1 P_LUTL
    s_waitcnt vmcnt(0)
    s_barrier
    s_cmp_lg_u32 s3, 15
    s_cbranch_scc1 P_PUB_1
    v_mov_b32 v4, 1
    s_mov_b64 exec, 1
    buffer_atomic_add v4, off, s[12:15], 0 offset:96 sc0
    s_waitcnt vmcnt(0)
    v_cmp_eq_u32 vcc, 4, v4
    s_and_b64 exec, exec, vcc
    s_cbranch_execz P_PUB_1_x
    v_mov_b32 v4, 5
    buffer_store_dword v4, off, s[12:15], 0 offset:224 sc1
P_PUB_1_x:
    s_mov_b64 exec, -1
P_PUB_1:
    s_branch M_ENTRY
P_NOTL:
    s_cmp_ge_u32 s101, 120
    s_cbranch_scc1 P_TWG
    s_mul_i32 s5, s101, 13344
    v_add_u32 v20, s5, v3
    buffer_load_dwordx4 v[4:7], v20, s[44:47], 0 offen nt
    buffer_load_dwordx4 v[12:15], v20, s[48:51], 0 offen nt
    s_mov_b32 s34, 1600000
    s_movk_i32 s35, 834
    v_cmp_gt_u32 s[6:7], s35, v0
    v_cmp_gt_u32 s[68:69], s34, v20
    s_and_b64 s[6:7], s[68:69], s[6:7]
    s_lshl_b32 s34, s3, 10
    s_add_u32 s34, s34, 512
    s_add_u32 m0, s34, 0
    v_add_u32 v22, 0, v3
    buffer_load_dwordx4 v22, s[40:43], 0 offen lds
    s_add_u32 m0, s34, 16384
    v_add_u32 v22, 16384, v3
    buffer_load_dwordx4 v22, s[40:43], 0 offen lds
    s_add_u32 m0, s34, 32768
    v_add_u32 v22, 32768, v3
    buffer_load_dwordx4 v22, s[40:43], 0 offen lds
    s_add_u32 m0, s34, 49152
    v_add_u32 v22, 49152, v3
    buffer_load_dwordx4 v22, s[40:43], 0 offen lds
    s_cmp_ge_u32 s3, 10
    s_cbranch_scc1 P_A2
    s_add_u32 m0, s34, 65536
    v_add_u32 v22, 65536, v3
    buffer_load_dwordx4 v22, s[40:43], 0 offen lds
P_A2:
    v_lshlrev_b32 v22, 2, v2
    v_mov_b32 v23, 0
    ds_write_b32 v22, v23 offset:0
    ds_write_b32 v22, v23 offset:256
    v_mov_b32 v23, 1
    s_mov_b32 s4, 0
    s_mov_b32 s8, 0x322bcc77
    s_mov_b32 s9, 1084030976
    s_movk_i32 s10, -196
    s_mov_b32 s11, 512
    s_mov_b32 s34, 1015021568
    s_mov_b32 s35, 953286656
    v_mov_b32 v20, 952104960
    v_mov_b32 v21, 1014890496
    s_waitcnt vmcnt(0) lgkmcnt(0)
    s_barrier
    v_lshrrev_b32 v100, 2, v0
    v_and_b32 v101, 3, v0
    s_mul_i32 s5, s93, 200704
    s_lshl_b32 s68, s92, 6
    s_add_u32 s5, s5, s68
    s_add_u32 s5, s5, 256
    v_lshl_add_u32 v101, v101, 4, s5
    s_lshl_b32 s5, s3, 10
    s_add_u32 s5, s5, 91136
    v_mul_u32_u24 v102, 21846, v100
    v_lshrrev_b32 v102, 16, v102
    v_add_u32 v102, v102, v100
    s_add_u32 m0, s5, 0
    v_lshl_add_u32 v102, v102, 8, v101
    buffer_load_dwordx4 v102, s[36:39], 0 offen lds
    v_add_u32 v100, 256, v100
    v_mul_u32_u24 v102, 21846, v100
    v_lshrrev_b32 v102, 16, v102
    v_add_u32 v102, v102, v100
    s_add_u32 m0, s5, 16384
    v_lshl_add_u32 v102, v102, 8, v101
    buffer_load_dwordx4 v102, s[36:39], 0 offen lds
    v_add_u32 v100, 256, v100
    s_cmp_ge_u32 s3, 5
    s_cbranch_scc1 P_NS3
    v_mul_u32_u24 v102, 21846, v100
    v_lshrrev_b32 v102, 16, v102
    v_add_u32 v102, v102, v100
    s_add_u32 m0, s5, 32768
    v_lshl_add_u32 v102, v102, 8, v101
    buffer_load_dwordx4 v102, s[36:39], 0 offen lds
    v_add_u32 v100, 256, v100
P_NS3:
P_ALOOP:
    s_mov_b64 s[84:85], 0
    s_mov_b64 s[86:87], 0
    s_mov_b64 s[88:89], 0
    s_mov_b64 s[90:91], 0
    s_cmp_ge_u32 s3, 14
    s_cbranch_scc1 P_A3
    v_mul_u32_u24 v98, 6, v4
    ds_read_u16_d16_hi v64, v98 offset:512
    ds_read_u16_d16_hi v65, v98 offset:514
    ds_read_u16_d16_hi v66, v98 offset:516
    v_mul_u32_u24 v99, 6, v12
    ds_read_u16_d16_hi v67, v99 offset:512
    ds_read_u16_d16_hi v68, v99 offset:514
    ds_read_u16_d16_hi v69, v99 offset:516
    v_mul_u32_u24 v98, 6, v5
    ds_read_u16_d16_hi v70, v98 offset:512
    ds_read_u16_d16_hi v71, v98 offset:514
    ds_read_u16_d16_hi v72, v98 offset:516
    v_mul_u32_u24 v99, 6, v13
    ds_read_u16_d16_hi v73, v99 offset:512
    ds_read_u16_d16_hi v74, v99 offset:514
    ds_read_u16_d16_hi v75, v99 offset:516
    s_waitcnt lgkmcnt(6)
    v_sub_f32 v64, v64, v67
    v_sub_f32 v65, v65, v68
    v_sub_f32 v66, v66, v69
    v_mul_u32_u24 v98, 6, v6
    ds_read_u16_d16_hi v76, v98 offset:512
    ds_read_u16_d16_hi v77, v98 offset:514
    ds_read_u16_d16_hi v78, v98 offset:516
    v_mul_u32_u24 v99, 6, v14
    ds_read_u16_d16_hi v79, v99 offset:512
    ds_read_u16_d16_hi v80, v99 offset:514
    ds_read_u16_d16_hi v81, v99 offset:516
    v_cvt_pk_bf16_f32 v97, v64, v65
    v_cvt_pk_bf16_f32 v66, v66, v66
    v_lshlrev_b32 v64, 16, v97
    v_and_b32 v65, 0xffff0000, v97
    v_and_b32 v66, 0xffff0000, v66
    v_mul_f32 v94, v64, v64
    v_mul_f32 v95, v65, v65
    v_mul_f32 v96, v66, v66
    v_cvt_pk_bf16_f32 v97, v94, v95
    v_cvt_pk_bf16_f32 v96, v96, v96
    v_lshlrev_b32 v94, 16, v97
    v_and_b32 v95, 0xffff0000, v97
    v_and_b32 v96, 0xffff0000, v96
    v_add_f32 v94, v94, v95
    v_add_f32 v94, v94, v96
    v_cvt_pk_bf16_f32 v94, v94, v94
    v_and_b32 v94, 0xffff0000, v94
    v_add_f32 v94, s8, v94
    v_cvt_pk_bf16_f32 v94, v94, v94
    v_and_b32 v94, 0xffff0000, v94
    v_sqrt_f32 v94, v94
    v_mul_u32_u24 v48, 2675, v12
    v_cvt_pk_bf16_f32 v94, v94, v94
    v_and_b32 v94, 0xffff0000, v94
    v_rcp_f32 v95, v94
    v_lshrrev_b32 v48, 19, v48
    v_cmp_gt_u32 s[84:85], s9, v94
    v_mad_i32_i24 v97, v48, s10, v12
    v_lshl_add_u32 v48, v48, 2, s4
    s_and_b64 s[84:85], s[84:85], s[6:7]
    v_mul_f32 v95, 0x3e800000, v95
    v_mul_f32 v64, v64, v95
    v_mul_f32 v65, v65, v95
    v_mul_f32 v66, v66, v95
    v_cmp_le_u32 s[68:69], s34, v94
    v_cmp_eq_u32 vcc, s35, v94
    v_max_u32 v94, 952172544, v94
    v_cvt_pk_bf16_f32 v24, v64, v65
    v_cndmask_b32 v95, v20, v21, s[68:69]
    v_cvt_pk_bf16_f32 v67, v66, 0
    v_sub_u32 v94, v94, v95
    v_lshl_or_b32 v25, v4, 16, v67
    v_lshrrev_b32 v94, 11, v94
    v_cndmask_b32_e64 v94, v94, 32, vcc
    v_lshl_or_b32 v26, v97, 18, v94
    s_waitcnt lgkmcnt(6)
    v_sub_f32 v70, v70, v73
    v_sub_f32 v71, v71, v74
    v_sub_f32 v72, v72, v75
    v_mul_u32_u24 v98, 6, v7
    ds_read_u16_d16_hi v82, v98 offset:512
    ds_read_u16_d16_hi v83, v98 offset:514
    ds_read_u16_d16_hi v84, v98 offset:516
    v_mul_u32_u24 v99, 6, v15
    ds_read_u16_d16_hi v85, v99 offset:512
    ds_read_u16_d16_hi v86, v99 offset:514
    ds_read_u16_d16_hi v87, v99 offset:516
    v_cvt_pk_bf16_f32 v97, v70, v71
    v_cvt_pk_bf16_f32 v72, v72, v72
    v_lshlrev_b32 v70, 16, v97
    v_and_b32 v71, 0xffff0000, v97
    v_and_b32 v72, 0xffff0000, v72
    v_mul_f32 v94, v70, v70
    v_mul_f32 v95, v71, v71
    v_mul_f32 v96, v72, v72
    v_cvt_pk_bf16_f32 v97, v94, v95
    v_cvt_pk_bf16_f32 v96, v96, v96
    v_lshlrev_b32 v94, 16, v97
    v_and_b32 v95, 0xffff0000, v97
    v_and_b32 v96, 0xffff0000, v96
    v_add_f32 v94, v94, v95
    v_add_f32 v94, v94, v96
    v_cvt_pk_bf16_f32 v94, v94, v94
    v_and_b32 v94, 0xffff0000, v94
    v_add_f32 v94, s8, v94
    v_cvt_pk_bf16_f32 v94, v94, v94
    v_and_b32 v94, 0xffff0000, v94
    v_sqrt_f32 v94, v94
    v_mul_u32_u24 v49, 2675, v13
    v_cvt_pk_bf16_f32 v94, v94, v94
    v_and_b32 v94, 0xffff0000, v94
    v_rcp_f32 v95, v94
    v_lshrrev_b32 v49, 19, v49
    v_cmp_gt_u32 s[86:87], s9, v94
    v_mad_i32_i24 v97, v49, s10, v13
    v_lshl_add_u32 v49, v49, 2, s4
    s_and_b64 s[86:87], s[86:87], s[6:7]
    v_mul_f32 v95, 0x3e800000, v95
    v_mul_f32 v70, v70, v95
    v_mul_f32 v71, v71, v95
    v_mul_f32 v72, v72, v95
    v_cmp_le_u32 s[68:69], s34, v94
    v_cmp_eq_u32 vcc, s35, v94
    v_max_u32 v94, 952172544, v94
    v_cvt_pk_bf16_f32 v27, v70, v71
    v_cndmask_b32 v95, v20, v21, s[68:69]
    v_cvt_pk_bf16_f32 v73, v72, 0
    v_sub_u32 v94, v94, v95
    v_lshl_or_b32 v28, v5, 16, v73
    v_lshrrev_b32 v94, 11, v94
    v_cndmask_b32_e64 v94, v94, 32, vcc
    v_lshl_or_b32 v29, v97, 18, v94
    s_waitcnt lgkmcnt(6)
    v_sub_f32 v76, v76, v79
    v_sub_f32 v77, v77, v80
    v_sub_f32 v78, v78, v81
    v_cvt_pk_bf16_f32 v97, v76, v77
    v_cvt_pk_bf16_f32 v78, v78, v78
    v_lshlrev_b32 v76, 16, v97
    v_and_b32 v77, 0xffff0000, v97
    v_and_b32 v78, 0xffff0000, v78
    v_mul_f32 v94, v76, v76
    v_mul_f32 v95, v77, v77
    v_mul_f32 v96, v78, v78
    v_cvt_pk_bf16_f32 v97, v94, v95
    v_cvt_pk_bf16_f32 v96, v96, v96
    v_lshlrev_b32 v94, 16, v97
    v_and_b32 v95, 0xffff0000, v97
    v_and_b32 v96, 0xffff0000, v96
    v_add_f32 v94, v94, v95
    v_add_f32 v94, v94, v96
    v_cvt_pk_bf16_f32 v94, v94, v94
    v_and_b32 v94, 0xffff0000, v94
    v_add_f32 v94, s8, v94
    v_cvt_pk_bf16_f32 v94, v94, v94
    v_and_b32 v94, 0xffff0000, v94
    v_sqrt_f32 v94, v94
    v_mul_u32_u24 v50, 2675, v14
    v_cvt_pk_bf16_f32 v94, v94, v94
    v_and_b32 v94, 0xffff0000, v94
    v_rcp_f32 v95, v94
    v_lshrrev_b32 v50, 19, v50
    v_cmp_gt_u32 s[88:89], s9, v94
    v_mad_i32_i24 v97, v50, s10, v14
    v_lshl_add_u32 v50, v50, 2, s4
    s_and_b64 s[88:89], s[88:89], s[6:7]
    v_mul_f32 v95, 0x3e800000, v95
    v_mul_f32 v76, v76, v95
    v_mul_f32 v77, v77, v95
    v_mul_f32 v78, v78, v95
    v_cmp_le_u32 s[68:69], s34, v94
    v_cmp_eq_u32 vcc, s35, v94
    v_max_u32 v94, 952172544, v94
    v_cvt_pk_bf16_f32 v30, v76, v77
    v_cndmask_b32 v95, v20, v21, s[68:69]
    v_cvt_pk_bf16_f32 v79, v78, 0
    v_sub_u32 v94, v94, v95
    v_lshl_or_b32 v31, v6, 16, v79
    v_lshrrev_b32 v94, 11, v94
    v_cndmask_b32_e64 v94, v94, 32, vcc
    v_lshl_or_b32 v32, v97, 18, v94
    s_waitcnt lgkmcnt(0)
    v_sub_f32 v82, v82, v85
    v_sub_f32 v83, v83, v86
    v_sub_f32 v84, v84, v87
    v_cvt_pk_bf16_f32 v97, v82, v83
    v_cvt_pk_bf16_f32 v84, v84, v84
    v_lshlrev_b32 v82, 16, v97
    v_and_b32 v83, 0xffff0000, v97
    v_and_b32 v84, 0xffff0000, v84
    v_mul_f32 v94, v82, v82
    v_mul_f32 v95, v83, v83
    v_mul_f32 v96, v84, v84
    v_cvt_pk_bf16_f32 v97, v94, v95
    v_cvt_pk_bf16_f32 v96, v96, v96
    v_lshlrev_b32 v94, 16, v97
    v_and_b32 v95, 0xffff0000, v97
    v_and_b32 v96, 0xffff0000, v96
    v_add_f32 v94, v94, v95
    v_add_f32 v94, v94, v96
    v_cvt_pk_bf16_f32 v94, v94, v94
    v_and_b32 v94, 0xffff0000, v94
    v_add_f32 v94, s8, v94
    v_cvt_pk_bf16_f32 v94, v94, v94
    v_and_b32 v94, 0xffff0000, v94
    v_sqrt_f32 v94, v94
    v_mul_u32_u24 v51, 2675, v15
    v_cvt_pk_bf16_f32 v94, v94, v94
    v_and_b32 v94, 0xffff0000, v94
    v_rcp_f32 v95, v94
    v_lshrrev_b32 v51, 19, v51
    v_cmp_gt_u32 s[90:91], s9, v94
    v_mad_i32_i24 v97, v51, s10, v15
    v_lshl_add_u32 v51, v51, 2, s4
    s_and_b64 s[90:91], s[90:91], s[6:7]
    v_mul_f32 v95, 0x3e800000, v95
    v_mul_f32 v82, v82, v95
    v_mul_f32 v83, v83, v95
    v_mul_f32 v84, v84, v95
    v_cmp_le_u32 s[68:69], s34, v94
    v_cmp_eq_u32 vcc, s35, v94
    v_max_u32 v94, 952172544, v94
    v_cvt_pk_bf16_f32 v33, v82, v83
    v_cndmask_b32 v95, v20, v21, s[68:69]
    v_cvt_pk_bf16_f32 v85, v84, 0
    v_sub_u32 v94, v94, v95
    v_lshl_or_b32 v34, v7, 16, v85
    v_lshrrev_b32 v94, 11, v94
    v_cndmask_b32_e64 v94, v94, 32, vcc
    v_lshl_or_b32 v35, v97, 18, v94
    s_mov_b64 exec, s[84:85]
    ds_add_rtn_u32 v56, v48, v23 offset:0
    s_mov_b64 exec, s[86:87]
    ds_add_rtn_u32 v57, v49, v23 offset:0
    s_mov_b64 exec, s[88:89]
    ds_add_rtn_u32 v58, v50, v23 offset:0
    s_mov_b64 exec, s[90:91]
    ds_add_rtn_u32 v59, v51, v23 offset:0
    s_mov_b64 exec, -1
P_A3:
    s_waitcnt lgkmcnt(0)
    s_barrier
    ds_read_b32 v88, v22 offset:0
    v_add_u32 v22, 256, v22
    s_waitcnt lgkmcnt(0)
    v_mov_b32 v89, v88
    s_nop 1
    v_add_u32_dpp v89, v89, v89 row_shr:1 row_mask:0xf bank_mask:0xf bound_ctrl:0
    s_nop 1
    v_add_u32_dpp v89, v89, v89 row_shr:2 row_mask:0xf bank_mask:0xf bound_ctrl:0
    s_nop 1
    v_add_u32_dpp v89, v89, v89 row_shr:4 row_mask:0xf bank_mask:0xf bound_ctrl:0
    s_nop 1
    v_add_u32_dpp v89, v89, v89 row_shr:8 row_mask:0xf bank_mask:0xf bound_ctrl:0
    s_nop 1
    v_add_u32_dpp v89, v89, v89 row_bcast:15 row_mask:0xa bank_mask:0xf
    s_nop 1
    v_add_u32_dpp v89, v89, v89 row_bcast:31 row_mask:0xc bank_mask:0xf
    s_nop 0
    v_readlane_b32 s34, v89, 63
    v_sub_u32 v89, v89, v88
    ds_bpermute_b32 v48, v48, v89
    ds_bpermute_b32 v49, v49, v89
    ds_bpermute_b32 v50, v50, v89
    ds_bpermute_b32 v51, v51, v89
    v_lshl_or_b32 v60, v88, 16, v89
    s_waitcnt lgkmcnt(0)
    v_add_u32 v48, v48, v56
    v_mad_u32_u24 v48, v48, 12, s11
    s_mov_b64 exec, s[84:85]
    ds_write2_b32 v48, v24, v25 offset0:0 offset1:1
    ds_write_b32 v48, v26 offset:8
    s_mov_b64 exec, -1
    v_add_u32 v49, v49, v57
    v_mad_u32_u24 v49, v49, 12, s11
    s_mov_b64 exec, s[86:87]
    ds_write2_b32 v49, v27, v28 offset0:0 offset1:1
    ds_write_b32 v49, v29 offset:8
    s_mov_b64 exec, -1
    v_add_u32 v50, v50, v58
    v_mad_u32_u24 v50, v50, 12, s11
    s_mov_b64 exec, s[88:89]
    ds_write2_b32 v50, v30, v31 offset0:0 offset1:1
    ds_write_b32 v50, v32 offset:8
    s_mov_b64 exec, -1
    v_add_u32 v51, v51, v59
    v_mad_u32_u24 v51, v51, 12, s11
    s_mov_b64 exec, s[90:91]
    ds_write2_b32 v51, v33, v34 offset0:0 offset1:1
    ds_write_b32 v51, v35 offset:8
    s_mov_b64 exec, -1
    s_waitcnt lgkmcnt(0)
    s_barrier
    s_mul_i32 s34, s34, 12
    s_mul_i32 s5, s101, 40320
    s_add_u32 s5, s5, s11
    s_add_u32 s5, s5, 21110272
    v_add_u32 v88, s11, v3
    s_lshl_b32 s35, s3, 10
    s_cmp_ge_u32 s35, s34
    s_cbranch_scc1 P_A5
    ds_read_b128 v[36:39], v88 offset:0
    v_add_u32 v90, 0, v3
    v_cmp_gt_u32 vcc, s34, v90
    s_add_u32 s35, s35, 16384
    s_mov_b64 exec, vcc
    s_waitcnt lgkmcnt(0)
    buffer_store_dwordx4 v[36:39], v90, s[64:67], s5 offen sc1
    s_mov_b64 exec, -1
    s_cmp_ge_u32 s35, s34
    s_cbranch_scc1 P_A5
    ds_read_b128 v[40:43], v88 offset:16384
    v_add_u32 v90, 16384, v3
    v_cmp_gt_u32 vcc, s34, v90
    s_add_u32 s35, s35, 16384
    s_mov_b64 exec, vcc
    s_waitcnt lgkmcnt(0)
    buffer_store_dwordx4 v[40:43], v90, s[64:67], s5 offen sc1
    s_mov_b64 exec, -1
    s_cmp_ge_u32 s35, s34
    s_cbranch_scc1 P_A5
    ds_read_b128 v[44:47], v88 offset:32768
    v_add_u32 v90, 32768, v3
    v_cmp_gt_u32 vcc, s34, v90
    s_add_u32 s35, s35, 16384
    s_mov_b64 exec, vcc
    s_waitcnt lgkmcnt(0)
    buffer_store_dwordx4 v[44:47], v90, s[64:67], s5 offen sc1
    s_mov_b64 exec, -1
P_A5:
    s_cmp_lg_u32 s3, 15
    s_cbranch_scc1 P_A4B
    s_mov_b64 exec, 1
    s_mov_b32 s34, 0
    buffer_load_dword v91, off, s[12:15], 0 offset:224
    s_branch P_A4M
P_A4L:
    buffer_load_dword v91, off, s[12:15], 0 offset:224 sc1
P_A4M:
    s_add_u32 s34, s34, 1
    s_waitcnt vmcnt(0)
    v_readfirstlane_b32 s5, v91
    s_cmp_gt_u32 s34, 1000000
    s_cselect_b32 s5, 5, s5
    s_cmp_lg_u32 s5, 5
    s_cbranch_scc1 P_A4L
    s_mov_b64 exec, -1
P_A4B:
    s_waitcnt vmcnt(0)
    s_barrier
    s_cmp_lg_u32 s3, 15
    s_cbranch_scc1 P_NOOFF
    v_lshlrev_b32 v61, 2, v2
    s_lshl_b32 s5, s101, 8
    s_add_u32 s5, s5, 21045248
    buffer_store_dword v60, v61, s[64:67], s5 offen sc1
P_NOOFF:
    s_branch M_ENTRY
P_TWG:
    s_sub_u32 s4, s101, 120
    s_lshr_b32 s6, s3, 2
    s_and_b32 s7, s3, 3
    v_lshrrev_b32 v32, 4, v0
    v_and_b32 v33, 15, v0
    v_lshrrev_b32 v34, 4, v2
    s_mul_i32 s9, s4, 96
    v_add_u32 v37, s9, v32
    v_lshlrev_b32 v37, 10, v37
    v_xor_b32 v38, v33, v32
    v_and_b32 v38, 15, v38
    v_lshl_add_u32 v37, v38, 4, v37
    s_lshl_b32 s5, s3, 10
    s_add_u32 m0, s5, 139264
    v_add_u32 v38, 0x10000, v37
    buffer_load_dwordx4 v37, s[36:39], 0 offen  lds
    s_cmp_ge_u32 s3, 8
    s_cbranch_scc1 P_T1
    s_add_u32 m0, s5, 155648
    s_nop 0
    buffer_load_dwordx4 v38, s[36:39], 0 offen  lds
P_T1:
    s_mov_b32 s5, 0
    buffer_load_dwordx4 v[64:67], v3, s[56:59], s5 offen
    s_mov_b32 s5, 16384
    buffer_load_dwordx4 v[68:71], v3, s[56:59], s5 offen
    v_mul_u32_u24 v63, 768, v32
    v_lshl_add_u32 v63, v33, 4, v63
    s_mov_b32 s68, 49152
    s_mov_b32 s69, 0xffff0000
    buffer_load_dwordx4 v[72:75], v63, s[60:63], 0 offen offset:0
    buffer_load_dwordx4 v[76:79], v63, s[60:63], 0 offen offset:256
    buffer_load_dwordx4 v[80:83], v63, s[60:63], 0 offen offset:512
    buffer_load_dwordx4 v[84:87], v63, s[60:63], s68 offen offset:0
    buffer_load_dwordx4 v[88:91], v63, s[60:63], s68 offen offset:256
    buffer_load_dwordx4 v[92:95], v63, s[60:63], s68 offen offset:512
    s_lshl_b32 s8, s6, 4
    s_add_u32 s5, s9, s8
    v_lshrrev_b32 v35, 2, v2
    v_add_u32 v35, s5, v35
    v_and_b32 v39, 3, v2
    v_lshlrev_b32 v36, 10, v35
    v_lshl_add_u32 v36, v39, 4, v36
    s_lshl_b32 s5, s7, 6
    v_add_u32 v36, s5, v36
    v_cmp_gt_u32 vcc, 12500, v35
    v_lshlrev_b32 v40, 8, v35
    v_lshl_add_u32 v40, v39, 4, v40
    v_mov_b32 v41, 1073741824
    v_add_u32 v37, 0x4000, v40
    v_cndmask_b32 v40, v41, v40, vcc
    v_cmp_gt_u32 vcc, 12436, v35
    v_lshrrev_b32 v38, 3, v2
    v_add_u32 v39, v39, v38
    v_cndmask_b32 v37, v41, v37, vcc
    v_and_b32 v39, 3, v39
    v_and_or_b32 v39, v2, -4, v39
    s_lshl_b32 s5, s3, 10
    s_add_u32 s5, s5, 139264
    v_lshl_add_u32 v39, v39, 4, s5
    v_lshrrev_b32 v38, 1, v33
    v_add_u32 v38, v38, v34
    v_and_b32 v38, 3, v38
    v_lshl_add_u32 v38, v33, 2, v38
    v_lshl_add_u32 v38, v38, 4, s5
    v_and_b32 v41, 0x33, v32
    v_and_b32 v42, 4, v32
    v_lshl_or_b32 v41, v42, 1, v41
    v_and_b32 v42, 8, v32
    v_lshrrev_b32 v42, 1, v42
    v_or_b32 v41, v41, v42
    v_mul_u32_u24 v41, 288, v41
    v_lshl_add_u32 v41, v33, 4, v41
    v_add_u32 v41, 102400, v41
    v_mul_u32_u24 v42, 800, v32
    v_lshrrev_b32 v43, 2, v33
    v_lshl_add_u32 v42, v43, 6, v42
    v_and_b32 v43, 3, v33
    v_lshl_add_u32 v42, v43, 3, v42
    v_add_u32 v43, 51200, v42
    v_and_b32 v44, 3, v2
    v_bfe_u32 v45, v2, 2, 2
    v_and_b32 v46, 1, v34
    v_lshrrev_b32 v47, 1, v34
    v_lshl_add_u32 v46, v46, 2, v45
    v_lshl_add_u32 v46, v47, 4, v46
    v_mul_u32_u24 v46, 288, v46
    v_lshl_add_u32 v46, v44, 3, v46
    s_and_b32 s10, s3, 7
    s_lshl_b32 s5, s10, 5
    s_add_u32 s5, s5, 102400
    v_add_u32 v46, s5, v46
    s_lshl_b32 s5, s7, 6
    v_lshl_add_u32 v47, v34, 2, v45
    v_mul_u32_u24 v47, 800, v47
    v_lshl_add_u32 v47, v44, 3, v47
    v_add_u32 v47, s5, v47
    v_add_u32 v48, 51200, v47
    s_lshl_b32 s8, s6, 12
    s_add_u32 s5, s8, 102400
    v_lshl_add_u32 v49, v2, 4, s5
    s_lshr_b32 s11, s3, 3
    s_mul_i32 s11, s11, 12288
    s_lshr_b32 s5, s10, 1
    s_lshl_b32 s5, s5, 10
    s_and_b32 s8, s10, 1
    s_lshl_b32 s8, s8, 3
    s_add_u32 s5, s5, s8
    s_add_u32 s5, s5, s11
    s_add_u32 s5, s5, 102400
    v_lshl_add_u32 v50, v2, 4, s5
    s_add_u32 s11, s11, 139264
    v_lshl_add_u32 v51, v33, 8, s11
    v_xor_b32 v44, v34, v33
    v_xor_b32 v32, 0, v44
    v_lshl_add_u32 v32, v32, 4, v51
    v_xor_b32 v33, 4, v44
    v_lshl_add_u32 v33, v33, 4, v51
    v_xor_b32 v34, 8, v44
    v_lshl_add_u32 v34, v34, 4, v51
    v_xor_b32 v35, 12, v44
    v_lshl_add_u32 v35, v35, 4, v51
    s_waitcnt vmcnt(6)
    ds_write_b128 v41, v[64:67] offset:0
    ds_write_b128 v41, v[68:71] offset:18432
    s_waitcnt lgkmcnt(0)
    s_barrier
    ds_read_b64_tr_b16 v[96:97], v46 offset:0
    ds_read_b64_tr_b16 v[98:99], v46 offset:2304
    ds_read_b64_tr_b16 v[100:101], v46 offset:9216
    ds_read_b64_tr_b16 v[102:103], v46 offset:11520
    ds_read_b64_tr_b16 v[104:105], v46 offset:18432
    ds_read_b64_tr_b16 v[106:107], v46 offset:20736
    ds_read_b64_tr_b16 v[108:109], v46 offset:27648
    ds_read_b64_tr_b16 v[110:111], v46 offset:29952
    ds_read_b128 v[4:7], v32 offset:0
    ds_read_b128 v[8:11], v33 offset:0
    ds_read_b128 v[12:15], v34 offset:0
    ds_read_b128 v[16:19], v35 offset:0
    s_waitcnt lgkmcnt(4)
    s_barrier
    ds_read_b128 v[112:115], v32 offset:4096
    ds_read_b128 v[116:119], v33 offset:4096
    ds_read_b128 v[120:123], v34 offset:4096
    ds_read_b128 v[124:127], v35 offset:4096
    buffer_load_dwordx4 v[20:23], v36, s[36:39], 0 offen offset:256
    buffer_load_dwordx4 v[24:27], v36, s[36:39], 0 offen offset:512
    buffer_load_dwordx4 v[28:31], v36, s[36:39], 0 offen offset:768
    s_mov_b32 s5, 0xbfb8aa3b
    s_waitcnt lgkmcnt(4)
    v_mfma_f32_16x16x32_bf16 v[64:67], v[96:99], v[4:7], 0
    v_mfma_f32_16x16x32_bf16 v[64:67], v[100:103], v[8:11], v[64:67]
    v_mfma_f32_16x16x32_bf16 v[64:67], v[104:107], v[12:15], v[64:67]
    v_mfma_f32_16x16x32_bf16 v[64:67], v[108:111], v[16:19], v[64:67]
    s_waitcnt lgkmcnt(0)
    v_mfma_f32_16x16x32_bf16 v[68:71], v[96:99], v[112:115], 0
    v_mfma_f32_16x16x32_bf16 v[68:71], v[100:103], v[116:119], v[68:71]
    v_mfma_f32_16x16x32_bf16 v[68:71], v[104:107], v[120:123], v[68:71]
    v_mfma_f32_16x16x32_bf16 v[68:71], v[108:111], v[124:127], v[68:71]
    ds_read_b128 v[4:7], v32 offset:8192
    ds_read_b128 v[8:11], v33 offset:8192
    ds_read_b128 v[12:15], v34 offset:8192
    ds_read_b128 v[16:19], v35 offset:8192
    v_cvt_pk_bf16_f32 v65, v64, v65
    v_lshlrev_b32 v64, 16, v65
    v_and_b32 v65, 0xffff0000, v65
    v_cvt_pk_bf16_f32 v67, v66, v67
    v_lshlrev_b32 v66, 16, v67
    v_and_b32 v67, 0xffff0000, v67
    v_mul_f32 v44, s5, v64
    v_mul_f32 v45, s5, v65
    v_mul_f32 v41, s5, v66
    v_mul_f32 v51, s5, v67
    v_exp_f32 v44, v44
    v_exp_f32 v45, v45
    v_exp_f32 v41, v41
    v_exp_f32 v51, v51
    s_nop 0
    v_add_f32 v44, 1.0, v44
    v_add_f32 v45, 1.0, v45
    v_add_f32 v41, 1.0, v41
    v_add_f32 v51, 1.0, v51
    v_rcp_f32 v44, v44
    v_rcp_f32 v45, v45
    v_rcp_f32 v41, v41
    v_rcp_f32 v51, v51
    s_nop 0
    v_mul_f32 v64, v64, v44
    v_mul_f32 v65, v65, v45
    v_mul_f32 v66, v66, v41
    v_mul_f32 v67, v67, v51
    v_cvt_pk_bf16_f32 v44, v64, v65
    v_cvt_pk_bf16_f32 v45, v66, v67
    ds_write_b64 v50, v[44:45] offset:0
    s_waitcnt lgkmcnt(1)
    v_mfma_f32_16x16x32_bf16 v[64:67], v[96:99], v[4:7], 0
    v_mfma_f32_16x16x32_bf16 v[64:67], v[100:103], v[8:11], v[64:67]
    v_mfma_f32_16x16x32_bf16 v[64:67], v[104:107], v[12:15], v[64:67]
    v_mfma_f32_16x16x32_bf16 v[64:67], v[108:111], v[16:19], v[64:67]
    s_waitcnt vmcnt(3)
    ds_write2_b64 v42, v[72:73], v[74:75] offset0:0 offset1:4
    ds_write2_b64 v42, v[76:77], v[78:79] offset0:32 offset1:36
    ds_write2_b64 v42, v[80:81], v[82:83] offset0:64 offset1:68
    ds_write2_b64 v43, v[84:85], v[86:87] offset0:0 offset1:4
    ds_write2_b64 v43, v[88:89], v[90:91] offset0:32 offset1:36
    ds_write2_b64 v43, v[92:93], v[94:95] offset0:64 offset1:68
    v_cvt_pk_bf16_f32 v69, v68, v69
    v_lshlrev_b32 v68, 16, v69
    v_and_b32 v69, 0xffff0000, v69
    v_cvt_pk_bf16_f32 v71, v70, v71
    v_lshlrev_b32 v70, 16, v71
    v_and_b32 v71, 0xffff0000, v71
    v_mul_f32 v44, s5, v68
    v_mul_f32 v45, s5, v69
    v_mul_f32 v41, s5, v70
    v_mul_f32 v51, s5, v71
    v_exp_f32 v44, v44
    v_exp_f32 v45, v45
    v_exp_f32 v41, v41
    v_exp_f32 v51, v51
    s_nop 0
    v_add_f32 v44, 1.0, v44
    v_add_f32 v45, 1.0, v45
    v_add_f32 v41, 1.0, v41
    v_add_f32 v51, 1.0, v51
    v_rcp_f32 v44, v44
    v_rcp_f32 v45, v45
    v_rcp_f32 v41, v41
    v_rcp_f32 v51, v51
    s_nop 0
    v_mul_f32 v68, v68, v44
    v_mul_f32 v69, v69, v45
    v_mul_f32 v70, v70, v41
    v_mul_f32 v71, v71, v51
    v_cvt_pk_bf16_f32 v44, v68, v69
    v_cvt_pk_bf16_f32 v45, v70, v71
    ds_write_b64 v50, v[44:45] offset:4096
    v_cvt_pk_bf16_f32 v65, v64, v65
    v_lshlrev_b32 v64, 16, v65
    v_and_b32 v65, 0xffff0000, v65
    v_cvt_pk_bf16_f32 v67, v66, v67
    v_lshlrev_b32 v66, 16, v67
    v_and_b32 v67, 0xffff0000, v67
    v_mul_f32 v44, s5, v64
    v_mul_f32 v45, s5, v65
    v_mul_f32 v41, s5, v66
    v_mul_f32 v51, s5, v67
    v_exp_f32 v44, v44
    v_exp_f32 v45, v45
    v_exp_f32 v41, v41
    v_exp_f32 v51, v51
    s_nop 0
    v_add_f32 v44, 1.0, v44
    v_add_f32 v45, 1.0, v45
    v_add_f32 v41, 1.0, v41
    v_add_f32 v51, 1.0, v51
    v_rcp_f32 v44, v44
    v_rcp_f32 v45, v45
    v_rcp_f32 v41, v41
    v_rcp_f32 v51, v51
    s_nop 0
    v_mul_f32 v64, v64, v44
    v_mul_f32 v65, v65, v45
    v_mul_f32 v66, v66, v41
    v_mul_f32 v67, v67, v51
    v_cvt_pk_bf16_f32 v44, v64, v65
    v_cvt_pk_bf16_f32 v45, v66, v67
    ds_write_b64 v50, v[44:45] offset:8192
    s_waitcnt lgkmcnt(0)
    s_barrier
    s_mov_b32 s34, 16781312
    s_lshl_b32 s5, s7, 6
    s_add_u32 s34, s34, s5
    s_mul_i32 s35, s7, 4194304
    s_add_u32 s35, s35, 4096
    ds_read_b128 v[4:7], v49 offset:0
    ds_read_b128 v[8:11], v49 offset:1024
    ds_read_b128 v[12:15], v49 offset:2048
    ds_read_b128 v[16:19], v49 offset:3072
    ds_read_b64_tr_b16 v[96:97], v47 offset:0
    ds_read_b64_tr_b16 v[98:99], v47 offset:12800
    ds_read_b64_tr_b16 v[100:101], v47 offset:25600
    ds_read_b64_tr_b16 v[102:103], v47 offset:38400
    ds_read_b64_tr_b16 v[104:105], v48 offset:0
    ds_read_b64_tr_b16 v[106:107], v48 offset:12800
    ds_read_b64_tr_b16 v[108:109], v48 offset:25600
    ds_read_b64_tr_b16 v[110:111], v48 offset:38400
    s_cmp_ge_u32 s3, 8
    s_cbranch_scc1 P_T2
    v_add_u32 v36, 0x10000, v36
    buffer_load_dwordx4 v[52:55], v36, s[36:39], 0 offen offset:256
    buffer_load_dwordx4 v[56:59], v36, s[36:39], 0 offen offset:512
    buffer_load_dwordx4 v[60:63], v36, s[36:39], 0 offen offset:768
P_T2:
    s_waitcnt lgkmcnt(7)
    ds_read_b64_tr_b16 v[112:113], v47 offset:32
    ds_read_b64_tr_b16 v[114:115], v47 offset:12832
    ds_read_b64_tr_b16 v[116:117], v47 offset:25632
    ds_read_b64_tr_b16 v[118:119], v47 offset:38432
    ds_read_b64_tr_b16 v[120:121], v48 offset:32
    ds_read_b64_tr_b16 v[122:123], v48 offset:12832
    ds_read_b64_tr_b16 v[124:125], v48 offset:25632
    ds_read_b64_tr_b16 v[126:127], v48 offset:38432
    s_waitcnt lgkmcnt(8)
    v_mfma_f32_16x16x32_bf16 v[64:67], v[96:99], v[4:7], 0
    v_mfma_f32_16x16x32_bf16 v[64:67], v[100:103], v[8:11], v[64:67]
    v_mfma_f32_16x16x32_bf16 v[64:67], v[104:107], v[12:15], v[64:67]
    v_mfma_f32_16x16x32_bf16 v[64:67], v[108:111], v[16:19], v[64:67]
    s_waitcnt lgkmcnt(7)
    ds_read_b64_tr_b16 v[96:97], v47 offset:256
    ds_read_b64_tr_b16 v[98:99], v47 offset:13056
    ds_read_b64_tr_b16 v[100:101], v47 offset:25856
    ds_read_b64_tr_b16 v[102:103], v47 offset:38656
    ds_read_b64_tr_b16 v[104:105], v48 offset:256
    ds_read_b64_tr_b16 v[106:107], v48 offset:13056
    ds_read_b64_tr_b16 v[108:109], v48 offset:25856
    ds_read_b64_tr_b16 v[110:111], v48 offset:38656
    s_waitcnt lgkmcnt(8)
    v_mfma_f32_16x16x32_bf16 v[68:71], v[112:115], v[4:7], 0
    v_mfma_f32_16x16x32_bf16 v[68:71], v[116:119], v[8:11], v[68:71]
    v_mfma_f32_16x16x32_bf16 v[68:71], v[120:123], v[12:15], v[68:71]
    v_mfma_f32_16x16x32_bf16 v[68:71], v[124:127], v[16:19], v[68:71]
    s_waitcnt lgkmcnt(7)
    ds_read_b64_tr_b16 v[112:113], v47 offset:288
    ds_read_b64_tr_b16 v[114:115], v47 offset:13088
    ds_read_b64_tr_b16 v[116:117], v47 offset:25888
    ds_read_b64_tr_b16 v[118:119], v47 offset:38688
    ds_read_b64_tr_b16 v[120:121], v48 offset:288
    ds_read_b64_tr_b16 v[122:123], v48 offset:13088
    ds_read_b64_tr_b16 v[124:125], v48 offset:25888
    ds_read_b64_tr_b16 v[126:127], v48 offset:38688
    s_waitcnt lgkmcnt(8)
    v_mfma_f32_16x16x32_bf16 v[72:75], v[96:99], v[4:7], 0
    v_mfma_f32_16x16x32_bf16 v[72:75], v[100:103], v[8:11], v[72:75]
    v_mfma_f32_16x16x32_bf16 v[72:75], v[104:107], v[12:15], v[72:75]
    v_mfma_f32_16x16x32_bf16 v[72:75], v[108:111], v[16:19], v[72:75]
    s_waitcnt lgkmcnt(7)
    ds_read_b64_tr_b16 v[96:97], v47 offset:512
    ds_read_b64_tr_b16 v[98:99], v47 offset:13312
    ds_read_b64_tr_b16 v[100:101], v47 offset:26112
    ds_read_b64_tr_b16 v[102:103], v47 offset:38912
    ds_read_b64_tr_b16 v[104:105], v48 offset:512
    ds_read_b64_tr_b16 v[106:107], v48 offset:13312
    ds_read_b64_tr_b16 v[108:109], v48 offset:26112
    ds_read_b64_tr_b16 v[110:111], v48 offset:38912
    s_waitcnt lgkmcnt(8)
    v_mfma_f32_16x16x32_bf16 v[76:79], v[112:115], v[4:7], 0
    v_mfma_f32_16x16x32_bf16 v[76:79], v[116:119], v[8:11], v[76:79]
    v_mfma_f32_16x16x32_bf16 v[76:79], v[120:123], v[12:15], v[76:79]
    v_mfma_f32_16x16x32_bf16 v[76:79], v[124:127], v[16:19], v[76:79]
    s_waitcnt lgkmcnt(7)
    ds_read_b64_tr_b16 v[112:113], v47 offset:544
    ds_read_b64_tr_b16 v[114:115], v47 offset:13344
    ds_read_b64_tr_b16 v[116:117], v47 offset:26144
    ds_read_b64_tr_b16 v[118:119], v47 offset:38944
    ds_read_b64_tr_b16 v[120:121], v48 offset:544
    ds_read_b64_tr_b16 v[122:123], v48 offset:13344
    ds_read_b64_tr_b16 v[124:125], v48 offset:26144
    ds_read_b64_tr_b16 v[126:127], v48 offset:38944
    s_waitcnt lgkmcnt(8)
    v_mfma_f32_16x16x32_bf16 v[80:83], v[96:99], v[4:7], 0
    v_mfma_f32_16x16x32_bf16 v[80:83], v[100:103], v[8:11], v[80:83]
    v_mfma_f32_16x16x32_bf16 v[80:83], v[104:107], v[12:15], v[80:83]
    v_mfma_f32_16x16x32_bf16 v[80:83], v[108:111], v[16:19], v[80:83]
    s_waitcnt lgkmcnt(0)
    v_mfma_f32_16x16x32_bf16 v[84:87], v[112:115], v[4:7], 0
    v_mfma_f32_16x16x32_bf16 v[84:87], v[116:119], v[8:11], v[84:87]
    v_mfma_f32_16x16x32_bf16 v[84:87], v[120:123], v[12:15], v[84:87]
    v_mfma_f32_16x16x32_bf16 v[84:87], v[124:127], v[16:19], v[84:87]
    v_cvt_pk_bf16_f32 v88, v64, v65
    v_cvt_pk_bf16_f32 v89, v66, v67
    v_cvt_pk_bf16_f32 v90, v68, v69
    v_cvt_pk_bf16_f32 v91, v70, v71
    ds_write_b128 v38, v[88:91]
    ds_read_b128 v[96:99], v39
    v_cvt_pk_bf16_f32 v92, v72, v73
    v_cvt_pk_bf16_f32 v93, v74, v75
    v_cvt_pk_bf16_f32 v94, v76, v77
    v_cvt_pk_bf16_f32 v95, v78, v79
    ds_write_b128 v38, v[92:95]
    ds_read_b128 v[100:103], v39
    v_cvt_pk_bf16_f32 v88, v80, v81
    v_cvt_pk_bf16_f32 v89, v82, v83
    v_cvt_pk_bf16_f32 v90, v84, v85
    v_cvt_pk_bf16_f32 v91, v86, v87
    ds_write_b128 v38, v[88:91]
    ds_read_b128 v[104:107], v39
    s_waitcnt lgkmcnt(4)
    buffer_store_dwordx4 v[96:99], v40, s[64:67], s34 offen sc1
    s_cmp_lt_u32 s3, 8
    s_cbranch_scc1 P_T3
    s_waitcnt vmcnt(1)
P_T3:
    s_waitcnt vmcnt(4) lgkmcnt(0)
    v_and_b32 v12, 0xffff, v100
    v_and_b32 v13, 0xffff0000, v100
    v_dot2_f32_bf16 v4, v20, v12, 0
    v_dot2_f32_bf16 v5, v20, v13, 0
    v_dot2_f32_bf16 v6, v24, v12, 0
    v_dot2_f32_bf16 v7, v24, v13, 0
    v_dot2_f32_bf16 v8, v28, v12, 0
    v_dot2_f32_bf16 v9, v28, v13, 0
    v_bfe_u32 v10, v104, 15, 1
    v_bfe_u32 v11, v104, 16, 15
    v_min_u32 v10, v10, v11
    v_cvt_pk_bf16_f32 v64, v4, v5
    v_cvt_pk_bf16_f32 v65, v6, v7
    v_cvt_pk_bf16_f32 v66, v8, v9
    v_mad_i32_i24 v67, v10, s69, v104
    buffer_store_dwordx4 v[64:67], v40, s[64:67], s35 offen offset:0 sc1
    v_and_b32 v12, 0xffff, v101
    v_and_b32 v13, 0xffff0000, v101
    v_dot2_f32_bf16 v4, v21, v12, 0
    v_dot2_f32_bf16 v5, v21, v13, 0
    v_dot2_f32_bf16 v6, v25, v12, 0
    v_dot2_f32_bf16 v7, v25, v13, 0
    v_dot2_f32_bf16 v8, v29, v12, 0
    v_dot2_f32_bf16 v9, v29, v13, 0
    v_bfe_u32 v10, v105, 15, 1
    v_bfe_u32 v11, v105, 16, 15
    v_min_u32 v10, v10, v11
    v_cvt_pk_bf16_f32 v68, v4, v5
    v_cvt_pk_bf16_f32 v69, v6, v7
    v_cvt_pk_bf16_f32 v70, v8, v9
    v_mad_i32_i24 v71, v10, s69, v105
    buffer_store_dwordx4 v[68:71], v40, s[64:67], s35 offen offset:64 sc1
    v_and_b32 v12, 0xffff, v102
    v_and_b32 v13, 0xffff0000, v102
    v_dot2_f32_bf16 v4, v22, v12, 0
    v_dot2_f32_bf16 v5, v22, v13, 0
    v_dot2_f32_bf16 v6, v26, v12, 0
    v_dot2_f32_bf16 v7, v26, v13, 0
    v_dot2_f32_bf16 v8, v30, v12, 0
    v_dot2_f32_bf16 v9, v30, v13, 0
    v_bfe_u32 v10, v106, 15, 1
    v_bfe_u32 v11, v106, 16, 15
    v_min_u32 v10, v10, v11
    v_cvt_pk_bf16_f32 v72, v4, v5
    v_cvt_pk_bf16_f32 v73, v6, v7
    v_cvt_pk_bf16_f32 v74, v8, v9
    v_mad_i32_i24 v75, v10, s69, v106
    buffer_store_dwordx4 v[72:75], v40, s[64:67], s35 offen offset:128 sc1
    v_and_b32 v12, 0xffff, v103
    v_and_b32 v13, 0xffff0000, v103
    v_dot2_f32_bf16 v4, v23, v12, 0
    v_dot2_f32_bf16 v5, v23, v13, 0
    v_dot2_f32_bf16 v6, v27, v12, 0
    v_dot2_f32_bf16 v7, v27, v13, 0
    v_dot2_f32_bf16 v8, v31, v12, 0
    v_dot2_f32_bf16 v9, v31, v13, 0
    v_bfe_u32 v10, v107, 15, 1
    v_bfe_u32 v11, v107, 16, 15
    v_min_u32 v10, v10, v11
    v_cvt_pk_bf16_f32 v76, v4, v5
    v_cvt_pk_bf16_f32 v77, v6, v7
    v_cvt_pk_bf16_f32 v78, v8, v9
    v_mad_i32_i24 v79, v10, s69, v107
    buffer_store_dwordx4 v[76:79], v40, s[64:67], s35 offen offset:192 sc1
    s_cmp_ge_u32 s3, 8
    s_cbranch_scc1 P_T4
    ds_read_b128 v[4:7], v49 offset:16384
    ds_read_b128 v[8:11], v49 offset:17408
    ds_read_b128 v[12:15], v49 offset:18432
    ds_read_b128 v[16:19], v49 offset:19456
    ds_read_b64_tr_b16 v[96:97], v47 offset:0
    ds_read_b64_tr_b16 v[98:99], v47 offset:12800
    ds_read_b64_tr_b16 v[100:101], v47 offset:25600
    ds_read_b64_tr_b16 v[102:103], v47 offset:38400
    ds_read_b64_tr_b16 v[104:105], v48 offset:0
    ds_read_b64_tr_b16 v[106:107], v48 offset:12800
    ds_read_b64_tr_b16 v[108:109], v48 offset:25600
    ds_read_b64_tr_b16 v[110:111], v48 offset:38400
    s_waitcnt lgkmcnt(7)
    ds_read_b64_tr_b16 v[112:113], v47 offset:32
    ds_read_b64_tr_b16 v[114:115], v47 offset:12832
    ds_read_b64_tr_b16 v[116:117], v47 offset:25632
    ds_read_b64_tr_b16 v[118:119], v47 offset:38432
    ds_read_b64_tr_b16 v[120:121], v48 offset:32
    ds_read_b64_tr_b16 v[122:123], v48 offset:12832
    ds_read_b64_tr_b16 v[124:125], v48 offset:25632
    ds_read_b64_tr_b16 v[126:127], v48 offset:38432
    s_waitcnt lgkmcnt(8)
    v_mfma_f32_16x16x32_bf16 v[64:67], v[96:99], v[4:7], 0
    v_mfma_f32_16x16x32_bf16 v[64:67], v[100:103], v[8:11], v[64:67]
    v_mfma_f32_16x16x32_bf16 v[64:67], v[104:107], v[12:15], v[64:67]
    v_mfma_f32_16x16x32_bf16 v[64:67], v[108:111], v[16:19], v[64:67]
    s_waitcnt lgkmcnt(7)
    ds_read_b64_tr_b16 v[96:97], v47 offset:256
    ds_read_b64_tr_b16 v[98:99], v47 offset:13056
    ds_read_b64_tr_b16 v[100:101], v47 offset:25856
    ds_read_b64_tr_b16 v[102:103], v47 offset:38656
    ds_read_b64_tr_b16 v[104:105], v48 offset:256
    ds_read_b64_tr_b16 v[106:107], v48 offset:13056
    ds_read_b64_tr_b16 v[108:109], v48 offset:25856
    ds_read_b64_tr_b16 v[110:111], v48 offset:38656
    s_waitcnt lgkmcnt(8)
    v_mfma_f32_16x16x32_bf16 v[68:71], v[112:115], v[4:7], 0
    v_mfma_f32_16x16x32_bf16 v[68:71], v[116:119], v[8:11], v[68:71]
    v_mfma_f32_16x16x32_bf16 v[68:71], v[120:123], v[12:15], v[68:71]
    v_mfma_f32_16x16x32_bf16 v[68:71], v[124:127], v[16:19], v[68:71]
    s_waitcnt lgkmcnt(7)
    ds_read_b64_tr_b16 v[112:113], v47 offset:288
    ds_read_b64_tr_b16 v[114:115], v47 offset:13088
    ds_read_b64_tr_b16 v[116:117], v47 offset:25888
    ds_read_b64_tr_b16 v[118:119], v47 offset:38688
    ds_read_b64_tr_b16 v[120:121], v48 offset:288
    ds_read_b64_tr_b16 v[122:123], v48 offset:13088
    ds_read_b64_tr_b16 v[124:125], v48 offset:25888
    ds_read_b64_tr_b16 v[126:127], v48 offset:38688
    s_waitcnt lgkmcnt(8)
    v_mfma_f32_16x16x32_bf16 v[72:75], v[96:99], v[4:7], 0
    v_mfma_f32_16x16x32_bf16 v[72:75], v[100:103], v[8:11], v[72:75]
    v_mfma_f32_16x16x32_bf16 v[72:75], v[104:107], v[12:15], v[72:75]
    v_mfma_f32_16x16x32_bf16 v[72:75], v[108:111], v[16:19], v[72:75]
    s_waitcnt lgkmcnt(7)
    ds_read_b64_tr_b16 v[96:97], v47 offset:512
    ds_read_b64_tr_b16 v[98:99], v47 offset:13312
    ds_read_b64_tr_b16 v[100:101], v47 offset:26112
    ds_read_b64_tr_b16 v[102:103], v47 offset:38912
    ds_read_b64_tr_b16 v[104:105], v48 offset:512
    ds_read_b64_tr_b16 v[106:107], v48 offset:13312
    ds_read_b64_tr_b16 v[108:109], v48 offset:26112
    ds_read_b64_tr_b16 v[110:111], v48 offset:38912
    s_waitcnt lgkmcnt(8)
    v_mfma_f32_16x16x32_bf16 v[76:79], v[112:115], v[4:7], 0
    v_mfma_f32_16x16x32_bf16 v[76:79], v[116:119], v[8:11], v[76:79]
    v_mfma_f32_16x16x32_bf16 v[76:79], v[120:123], v[12:15], v[76:79]
    v_mfma_f32_16x16x32_bf16 v[76:79], v[124:127], v[16:19], v[76:79]
    s_waitcnt lgkmcnt(7)
    ds_read_b64_tr_b16 v[112:113], v47 offset:544
    ds_read_b64_tr_b16 v[114:115], v47 offset:13344
    ds_read_b64_tr_b16 v[116:117], v47 offset:26144
    ds_read_b64_tr_b16 v[118:119], v47 offset:38944
    ds_read_b64_tr_b16 v[120:121], v48 offset:544
    ds_read_b64_tr_b16 v[122:123], v48 offset:13344
    ds_read_b64_tr_b16 v[124:125], v48 offset:26144
    ds_read_b64_tr_b16 v[126:127], v48 offset:38944
    s_waitcnt lgkmcnt(8)
    v_mfma_f32_16x16x32_bf16 v[80:83], v[96:99], v[4:7], 0
    v_mfma_f32_16x16x32_bf16 v[80:83], v[100:103], v[8:11], v[80:83]
    v_mfma_f32_16x16x32_bf16 v[80:83], v[104:107], v[12:15], v[80:83]
    v_mfma_f32_16x16x32_bf16 v[80:83], v[108:111], v[16:19], v[80:83]
    s_waitcnt lgkmcnt(0)
    v_mfma_f32_16x16x32_bf16 v[84:87], v[112:115], v[4:7], 0
    v_mfma_f32_16x16x32_bf16 v[84:87], v[116:119], v[8:11], v[84:87]
    v_mfma_f32_16x16x32_bf16 v[84:87], v[120:123], v[12:15], v[84:87]
    v_mfma_f32_16x16x32_bf16 v[84:87], v[124:127], v[16:19], v[84:87]
    v_cvt_pk_bf16_f32 v88, v64, v65
    v_cvt_pk_bf16_f32 v89, v66, v67
    v_cvt_pk_bf16_f32 v90, v68, v69
    v_cvt_pk_bf16_f32 v91, v70, v71
    ds_write_b128 v38, v[88:91]
    ds_read_b128 v[96:99], v39
    v_cvt_pk_bf16_f32 v92, v72, v73
    v_cvt_pk_bf16_f32 v93, v74, v75
    v_cvt_pk_bf16_f32 v94, v76, v77
    v_cvt_pk_bf16_f32 v95, v78, v79
    ds_write_b128 v38, v[92:95]
    ds_read_b128 v[100:103], v39
    v_cvt_pk_bf16_f32 v88, v80, v81
    v_cvt_pk_bf16_f32 v89, v82, v83
    v_cvt_pk_bf16_f32 v90, v84, v85
    v_cvt_pk_bf16_f32 v91, v86, v87
    ds_write_b128 v38, v[88:91]
    ds_read_b128 v[104:107], v39
    s_waitcnt lgkmcnt(4)
    buffer_store_dwordx4 v[96:99], v37, s[64:67], s34 offen sc1
    s_waitcnt vmcnt(6) lgkmcnt(0)
    v_and_b32 v12, 0xffff, v100
    v_and_b32 v13, 0xffff0000, v100
    v_dot2_f32_bf16 v4, v52, v12, 0
    v_dot2_f32_bf16 v5, v52, v13, 0
    v_dot2_f32_bf16 v6, v56, v12, 0
    v_dot2_f32_bf16 v7, v56, v13, 0
    v_dot2_f32_bf16 v8, v60, v12, 0
    v_dot2_f32_bf16 v9, v60, v13, 0
    v_bfe_u32 v10, v104, 15, 1
    v_bfe_u32 v11, v104, 16, 15
    v_min_u32 v10, v10, v11
    v_cvt_pk_bf16_f32 v64, v4, v5
    v_cvt_pk_bf16_f32 v65, v6, v7
    v_cvt_pk_bf16_f32 v66, v8, v9
    v_mad_i32_i24 v67, v10, s69, v104
    buffer_store_dwordx4 v[64:67], v37, s[64:67], s35 offen offset:0 sc1
    v_and_b32 v12, 0xffff, v101
    v_and_b32 v13, 0xffff0000, v101
    v_dot2_f32_bf16 v4, v53, v12, 0
    v_dot2_f32_bf16 v5, v53, v13, 0
    v_dot2_f32_bf16 v6, v57, v12, 0
    v_dot2_f32_bf16 v7, v57, v13, 0
    v_dot2_f32_bf16 v8, v61, v12, 0
    v_dot2_f32_bf16 v9, v61, v13, 0
    v_bfe_u32 v10, v105, 15, 1
    v_bfe_u32 v11, v105, 16, 15
    v_min_u32 v10, v10, v11
    v_cvt_pk_bf16_f32 v68, v4, v5
    v_cvt_pk_bf16_f32 v69, v6, v7
    v_cvt_pk_bf16_f32 v70, v8, v9
    v_mad_i32_i24 v71, v10, s69, v105
    buffer_store_dwordx4 v[68:71], v37, s[64:67], s35 offen offset:64 sc1
    v_and_b32 v12, 0xffff, v102
    v_and_b32 v13, 0xffff0000, v102
    v_dot2_f32_bf16 v4, v54, v12, 0
    v_dot2_f32_bf16 v5, v54, v13, 0
    v_dot2_f32_bf16 v6, v58, v12, 0
    v_dot2_f32_bf16 v7, v58, v13, 0
    v_dot2_f32_bf16 v8, v62, v12, 0
    v_dot2_f32_bf16 v9, v62, v13, 0
    v_bfe_u32 v10, v106, 15, 1
    v_bfe_u32 v11, v106, 16, 15
    v_min_u32 v10, v10, v11
    v_cvt_pk_bf16_f32 v72, v4, v5
    v_cvt_pk_bf16_f32 v73, v6, v7
    v_cvt_pk_bf16_f32 v74, v8, v9
    v_mad_i32_i24 v75, v10, s69, v106
    buffer_store_dwordx4 v[72:75], v37, s[64:67], s35 offen offset:128 sc1
    v_and_b32 v12, 0xffff, v103
    v_and_b32 v13, 0xffff0000, v103
    v_dot2_f32_bf16 v4, v55, v12, 0
    v_dot2_f32_bf16 v5, v55, v13, 0
    v_dot2_f32_bf16 v6, v59, v12, 0
    v_dot2_f32_bf16 v7, v59, v13, 0
    v_dot2_f32_bf16 v8, v63, v12, 0
    v_dot2_f32_bf16 v9, v63, v13, 0
    v_bfe_u32 v10, v107, 15, 1
    v_bfe_u32 v11, v107, 16, 15
    v_min_u32 v10, v10, v11
    v_cvt_pk_bf16_f32 v76, v4, v5
    v_cvt_pk_bf16_f32 v77, v6, v7
    v_cvt_pk_bf16_f32 v78, v8, v9
    v_mad_i32_i24 v79, v10, s69, v107
    buffer_store_dwordx4 v[76:79], v37, s[64:67], s35 offen offset:192 sc1
P_T4:
M_ENTRY:
    s_load_dwordx2 s[4:5], s[0:1], 0
    s_load_dwordx4 s[44:47], s[0:1], 56
    s_load_dwordx2 s[6:7], s[0:1], 80
    s_load_dwordx2 s[48:49], s[0:1], 72
    s_mov_b32 s32, s3
    s_and_b32 s3, s2, 7
    s_and_b32 s33, s3, 3
    s_lshr_b32 s3, s3, 2
    s_lshl_b32 s3, s3, 5
    s_lshr_b32 s34, s2, 3
    s_add_u32 s34, s34, s3
    s_mul_i32 s35, s34, 196
    s_mov_b32 s36, 0
    s_mov_b32 s37, 1
    s_mov_b32 s84, 0
    s_mov_b32 s38, 1
    s_mov_b32 s41, 0x05040100
    s_mov_b32 s42, 0x07060302
    s_waitcnt lgkmcnt(0)
    s_mov_b32 s20, s6
    s_and_b32 s21, s7, 0xffff
    s_mov_b32 s22, 78643200
    s_mov_b32 s23, 0x00020000
    s_mov_b32 s80, s48
    s_and_b32 s81, s49, 0xffff
    s_mov_b32 s82, 256
    s_mov_b32 s83, 0x00020000
    s_mov_b32 s12, s4
    s_and_b32 s13, s5, 0xffff
    s_mov_b32 s14, 12800000
    s_mov_b32 s15, 0x00020000
    s_mov_b32 s16, s46
    s_and_b32 s17, s47, 0xffff
    s_mov_b32 s18, 12800000
    s_mov_b32 s19, 0x00020000
    s_mov_b32 s24, s44
    s_and_b32 s25, s45, 0xffff
    s_mov_b32 s26, 12288
    s_mov_b32 s27, 0x00020000
    s_mul_i32 s3, s33, 4194304
    s_add_u32 s3, s3, 4096
    s_add_u32 s30, s6, s3
    s_addc_u32 s31, s7, 0
    s_and_b32 s31, s31, 0xffff
    s_add_u32 s28, s6, 16781312
    s_addc_u32 s29, s7, 0
    s_and_b32 s29, s29, 0xffff
    s_mov_b32 s10, 3200000
    s_mov_b32 s11, 0x00020000
M_ROUND:
    s_mov_b32 s8, s30
    s_mov_b32 s9, s31
    v_mbcnt_lo_u32_b32 v94, -1, 0
    v_mbcnt_hi_u32_b32 v94, -1, v94
    s_lshl_b32 s3, s32, 6
    v_add_u32 v95, s3, v94
    v_lshrrev_b32 v92, 4, v95
    v_and_b32 v93, 15, v94
    v_lshlrev_b32 v91, 4, v95
    v_lshrrev_b32 v89, 4, v94
    v_mul_u32_u24 v5, 3072, v89
    v_and_b32 v6, 3, v93
    v_lshrrev_b32 v7, 2, v93
    v_lshl_add_u32 v90, v6, 2, v7
    v_lshl_add_u32 v5, v90, 2, v5
    v_mov_b32 v8, 0
    v_mov_b32 v9, 0xffff0000
    v_mov_b32 v10, 0
    v_mov_b32 v11, 0xffff0000
    v_mov_b32 v12, 0
    v_mov_b32 v13, 0
    v_mov_b32 v14, 0
    v_mov_b32 v15, 0
    v_bfe_u32 v22, v94, 2, 2
    v_lshlrev_b32 v120, 4, v22
    v_lshl_add_u32 v120, v89, 2, v120
    v_and_b32 v23, 3, v94
    v_lshlrev_b32 v123, 3, v23
    s_mov_b32 s3, 129024
    v_add_u32 v123, s3, v123
    v_lshlrev_b32 v121, 2, v90
    v_lshlrev_b32 v122, 6, v23
    v_lshl_add_u32 v122, v89, 4, v122
    v_and_b32 v23, 4, v94
    v_lshl_add_u32 v122, v23, 1, v122
    v_lshlrev_b32 v124, 3, v89
    v_add_u32 v124, s3, v124
    v_lshlrev_b32 v125, 4, v93
    v_lshrrev_b32 v22, 1, v89
    v_and_b32 v23, 1, v89
    s_mov_b32 s3, 90944
    v_lshl_add_u32 v119, v94, 4, s3
    v_mul_u32_u24 v126, 192, v22
    v_lshl_add_u32 v126, v90, 2, v126
    v_add_u32 v126, s3, v126
    v_lshl_add_u32 v127, v23, 1, v126
    v_add_u32 v127, 128, v127
    v_lshl_add_u32 v126, v23, 6, v126
    v_lshrrev_b32 v22, 2, v94
    v_cmp_lt_u32 vcc, 2, v22
    v_and_b32 v23, 3, v94
    s_lshl_b32 s3, s33, 6
    s_add_u32 s3, s3, 256
    v_addc_co_u32 v22, vcc, 0, v22, vcc
    v_lshl_add_u32 v118, v23, 4, s3
    v_lshl_add_u32 v118, v22, 8, v118
    v_mov_b32 v16, 33
    s_cmp_lt_u32 s101, 120
    s_cbranch_scc1 M_NLP
    s_cmp_lg_u32 s32, 15
    s_cbranch_scc1 M_POLLE_3
    s_mov_b32 s5, 0
    s_mov_b64 exec, 1
    s_cmp_ge_u32 s101, 251
    s_cbranch_scc1 M_POLL_2
    buffer_load_dword v25, off, s[80:83], 0 offset:224
    s_waitcnt vmcnt(0)
    s_branch M_POLLR_5
M_POLL_2:
    buffer_load_dword v25, off, s[80:83], 0 offset:224 sc1
    s_waitcnt vmcnt(0)
M_POLLR_5:
    v_readfirstlane_b32 s4, v25
    s_add_u32 s5, s5, 1
    s_cmp_gt_u32 s5, 4000000
    s_cselect_b32 s4, 5, s4
    s_cmp_eq_u32 s4, 5
    s_cbranch_scc1 M_POLLX_4
    s_sleep 1
    s_branch M_POLL_2
M_POLLX_4:
    s_mov_b64 exec, -1
M_POLLE_3:
M_NLP:
    s_waitcnt vmcnt(0)
    s_barrier
    s_sub_u32 s3, s101, 120
    s_cmp_ge_u32 s3, 131
    s_cbranch_scc1 M_NPT_6
    s_cmp_eq_u32 s38, 0
    s_cbranch_scc1 M_NPT_6
    s_cmp_lg_u32 s32, 15
    s_cbranch_scc1 P_PUB_7
    v_mov_b32 v24, 1
    s_and_b32 s4, s101, 7
    s_lshl_b32 s4, s4, 8
    s_add_u32 s4, s4, 21084160
    s_mov_b64 exec, 1
    buffer_atomic_add v24, off, s[20:23], s4 sc0
    s_mov_b64 exec, -1
    v_mbcnt_lo_u32_b32 v25, -1, 0
    v_lshlrev_b32 v25, 8, v25
    s_and_b32 s4, s101, 7
    s_cmp_lt_u32 s4, 3
    s_cselect_b32 s4, 16, 15
    s_waitcnt vmcnt(0)
    v_readfirstlane_b32 s5, v24
    s_cmp_lg_u32 s4, s5
    s_cbranch_scc1 P_PUB_7
    v_mov_b32 v24, 1
    s_mov_b64 exec, 1
    buffer_atomic_add v24, off, s[80:83], 0 offset:64 sc0
    s_mov_b64 exec, -1
    s_waitcnt vmcnt(0)
    v_readfirstlane_b32 s5, v24
    s_cmp_lg_u32 s5, 7
    s_cbranch_scc1 P_PUB_7
    v_mov_b32 v24, 131
    s_mov_b32 s4, 21080064
    s_mov_b64 exec, 0xff
    buffer_store_dword v24, v25, s[20:23], s4 offen sc1
    s_mov_b64 exec, -1
P_PUB_7:
M_NPT_6:
    s_sub_u32 s3, s101, 120
    s_cmp_lt_u32 s3, 131
    s_cbranch_scc1 M_SU_8
    s_mul_i32 s5, s84, 33792
    s_add_u32 s5, s5, 20975616
    s_lshl_b32 s4, s32, 10
    s_add_u32 s4, s4, 129024
    s_cmp_lg_u32 s32, 0
    s_cbranch_scc1 M_NL3_9
    s_add_u32 m0, s4, 32768
    s_add_u32 s3, s5, 32768
    buffer_load_dwordx4 v91, s[20:23], s3 offen lds
M_NL3_9:
    s_add_u32 m0, s4, 0
    s_add_u32 s3, s5, 0
    buffer_load_dwordx4 v91, s[20:23], s3 offen lds
    s_add_u32 m0, s4, 16384
    s_add_u32 s3, s5, 16384
    buffer_load_dwordx4 v91, s[20:23], s3 offen lds
    s_sub_u32 s3, s32, 1
    s_cmp_ge_u32 s3, 4
    s_cbranch_scc1 M_NWS_10
    v_mul_u32_u24 v6, 3072, v89
    v_add_u32 v6, v6, v125
    s_lshl_b32 s4, s3, 10
    s_add_u32 m0, s4, 84992
    s_mul_i32 s3, s3, 768
    buffer_load_dwordx4 v6, s[24:27], s3 offen lds
M_NWS_10:
    s_sub_u32 s3, s32, 5
    s_cmp_ge_u32 s3, 8
    s_cbranch_scc1 M_NWV_11
    s_lshl_b32 s4, s3, 8
    s_add_u32 m0, s4, 89088
    s_and_b32 s4, s3, 3
    s_mul_i32 s4, s4, 768
    s_lshr_b32 s3, s3, 2
    s_lshl_b32 s3, s3, 8
    s_add_u32 s3, s3, s4
    s_lshl_b32 s4, s33, 6
    s_add_u32 s3, s3, s4
    s_add_u32 s3, s3, 256
    buffer_load_dword v5, s[24:27], s3 offen lds
M_NWV_11:
    ds_write_b128 v91, v[12:15]
    v_add_u32 v6, 18832, v91
    ds_write_b128 v6, v[8:11] offset:0
    ds_write_b128 v6, v[8:11] offset:16384
    ds_write_b128 v6, v[8:11] offset:32768
    ds_write_b128 v6, v[8:11] offset:49152
    v_add_u32 v7, 84368, v91
    v_cmp_gt_u32 vcc, 39, v95
    s_mov_b64 exec, vcc
    ds_write_b128 v7, v[8:11]
    s_mov_b64 exec, -1
    v_cmp_gt_u32 vcc, 153, v95
    s_mov_b64 exec, vcc
    ds_write_b128 v91, v[12:15] offset:16384
    s_mov_b64 exec, -1
M_SU_8:
    s_cmp_lt_u32 s101, 120
    s_cbranch_scc1 M_NSP
    s_sub_u32 s3, s101, 120
    s_cmp_lt_u32 s3, 131
    s_cbranch_scc1 M_NS3_12
    v_lshrrev_b32 v2, 2, v95
    v_and_b32 v3, 3, v94
    s_lshl_b32 s3, s35, 10
    s_lshl_b32 s4, s33, 6
    s_add_u32 s3, s3, s4
    s_add_u32 s3, s3, 256
    v_lshl_add_u32 v3, v3, 4, s3
    s_lshl_b32 s4, s32, 10
    s_add_u32 s4, s4, 91136
    v_mul_u32_u24 v4, 21846, v2
    v_lshrrev_b32 v4, 16, v4
    v_add_u32 v4, v4, v2
    s_add_u32 m0, s4, 0
    v_lshl_add_u32 v4, v4, 8, v3
    buffer_load_dwordx4 v4, s[12:15], 0 offen lds
    v_add_u32 v2, 256, v2
    v_mul_u32_u24 v4, 21846, v2
    v_lshrrev_b32 v4, 16, v4
    v_add_u32 v4, v4, v2
    s_add_u32 m0, s4, 16384
    v_lshl_add_u32 v4, v4, 8, v3
    buffer_load_dwordx4 v4, s[12:15], 0 offen lds
    v_add_u32 v2, 256, v2
    s_cmp_ge_u32 s32, 5
    s_cbranch_scc1 M_NS3_12
    v_mul_u32_u24 v4, 21846, v2
    v_lshrrev_b32 v4, 16, v4
    v_add_u32 v4, v4, v2
    s_add_u32 m0, s4, 32768
    v_lshl_add_u32 v4, v4, 8, v3
    buffer_load_dwordx4 v4, s[12:15], 0 offen lds
    v_add_u32 v2, 256, v2
M_NS3_12:
M_NSP:
    v_lshlrev_b32 v2, 9, v92
    s_lshl_b32 s6, s34, 2
    s_add_u32 s6, s6, 21045248
    s_cmp_eq_u32 s32, 15
    s_cbranch_scc1 M_OF0
    buffer_load_dword v0, v2, s[20:23], s6 offen sc1
    buffer_load_dword v1, v2, s[20:23], s6 offen offset:256 sc1
M_OF0:
    v_add_u32 v17, s36, v93
    s_mov_b32 s3, 80640
    v_mul_u32_u24 v18, s3, v92
    v_mad_u32_u24 v18, v17, 12, v18
    s_mov_b32 s5, 0
    s_cmp_eq_u32 s32, 15
    s_cbranch_scc1 M_OFX
M_OFL:
    s_waitcnt vmcnt(0)
    v_or_b32 v3, v0, v1
    v_cmp_gt_i32 vcc, 0, v3
    s_add_u32 s5, s5, 1
    s_cbranch_vccz M_OFX
    s_cmp_gt_u32 s5, 2000000
    s_cbranch_scc1 M_OFX
    s_sleep 8
    buffer_load_dword v0, v2, s[20:23], s6 offen sc1
    buffer_load_dword v1, v2, s[20:23], s6 offen offset:256 sc1
    s_branch M_OFL
M_OFX:
    v_cmp_gt_u32 vcc, 60, v92
    s_nop 0
    v_lshrrev_b32 v22, 16, v0
    v_and_b32 v20, 0xffff, v0
    v_cndmask_b32 v22, 0, v22, vcc
    v_mad_u32_u24 v20, v20, 12, v18
    v_sub_u32 v22, v22, v17
    v_lshrrev_b32 v23, 16, v1
    v_and_b32 v21, 0xffff, v1
    v_cndmask_b32 v23, 0, v23, vcc
    v_mad_u32_u24 v21, v21, 12, v18
    v_sub_u32 v23, v23, v17
    s_cmp_eq_u32 s37, 0
    s_cbranch_scc1 M_OLDWIN
    v_cmp_lt_i32 s[56:57], 0, v22
    v_cmp_lt_i32 s[58:59], 0, v23
    v_cmp_lt_i32 s[60:61], 16, v22
    v_cmp_lt_i32 s[62:63], 16, v23
    v_cmp_lt_i32 s[64:65], 32, v22
    v_cmp_lt_i32 s[66:67], 32, v23
    v_cmp_lt_i32 s[68:69], 48, v22
    v_cmp_lt_i32 s[70:71], 48, v23
    v_cmp_lt_i32 s[72:73], 64, v22
    v_cmp_lt_i32 s[74:75], 64, v23
    v_max_i32 v18, v22, v23
    v_cmp_lt_i32 vcc, 80, v18
    s_cmp_lg_u64 vcc, 0
    s_cselect_b32 s40, 2, 0
M_OLDWIN:
    s_mov_b32 s4, 21110784
    s_mov_b32 s5, 21151104
    s_mov_b64 exec, s[56:57]
    s_cbranch_execz M_LD_13
    buffer_load_dwordx3 v[32:34], v20, s[20:23], s4 offen offset:0
M_LD_13:
    s_mov_b64 exec, s[58:59]
    s_cbranch_execz M_LD_14
    buffer_load_dwordx3 v[36:38], v21, s[20:23], s5 offen offset:0
M_LD_14:
    s_mov_b64 exec, s[60:61]
    s_cbranch_execz M_LD_15
    buffer_load_dwordx3 v[40:42], v20, s[20:23], s4 offen offset:192
M_LD_15:
    s_mov_b64 exec, s[62:63]
    s_cbranch_execz M_LD_16
    buffer_load_dwordx3 v[44:46], v21, s[20:23], s5 offen offset:192
M_LD_16:
    s_mov_b64 exec, s[64:65]
    s_cbranch_execz M_LD_17
    buffer_load_dwordx3 v[48:50], v20, s[20:23], s4 offen offset:384
M_LD_17:
    s_mov_b64 exec, s[66:67]
    s_cbranch_execz M_LD_18
    buffer_load_dwordx3 v[52:54], v21, s[20:23], s5 offen offset:384
M_LD_18:
    s_mov_b64 exec, s[68:69]
    s_cbranch_execz M_LD_19
    buffer_load_dwordx3 v[56:58], v20, s[20:23], s4 offen offset:576
M_LD_19:
    s_mov_b64 exec, s[70:71]
    s_cbranch_execz M_LD_20
    buffer_load_dwordx3 v[60:62], v21, s[20:23], s5 offen offset:576
M_LD_20:
    s_mov_b64 exec, s[72:73]
    s_cbranch_execz M_LD_21
    buffer_load_dwordx3 v[64:66], v20, s[20:23], s4 offen offset:768
M_LD_21:
    s_mov_b64 exec, s[74:75]
    s_cbranch_execz M_LD_22
    buffer_load_dwordx3 v[68:70], v21, s[20:23], s5 offen offset:768
M_LD_22:
    s_mov_b64 exec, -1
    s_sub_u32 s3, s101, 120
    s_cmp_lt_u32 s3, 131
    s_cbranch_scc0 M_SU_23
    s_mul_i32 s5, s84, 33792
    s_add_u32 s5, s5, 20975616
    s_lshl_b32 s4, s32, 10
    s_add_u32 s4, s4, 129024
    s_cmp_lg_u32 s32, 0
    s_cbranch_scc1 M_NL3_24
    s_add_u32 m0, s4, 32768
    s_add_u32 s3, s5, 32768
    buffer_load_dwordx4 v91, s[20:23], s3 offen lds
M_NL3_24:
    s_add_u32 m0, s4, 0
    s_add_u32 s3, s5, 0
    buffer_load_dwordx4 v91, s[20:23], s3 offen lds
    s_add_u32 m0, s4, 16384
    s_add_u32 s3, s5, 16384
    buffer_load_dwordx4 v91, s[20:23], s3 offen lds
    s_sub_u32 s3, s32, 1
    s_cmp_ge_u32 s3, 4
    s_cbranch_scc1 M_NWS_25
    v_mul_u32_u24 v6, 3072, v89
    v_add_u32 v6, v6, v125
    s_lshl_b32 s4, s3, 10
    s_add_u32 m0, s4, 84992
    s_mul_i32 s3, s3, 768
    buffer_load_dwordx4 v6, s[24:27], s3 offen lds
M_NWS_25:
    s_sub_u32 s3, s32, 5
    s_cmp_ge_u32 s3, 8
    s_cbranch_scc1 M_NWV_26
    s_lshl_b32 s4, s3, 8
    s_add_u32 m0, s4, 89088
    s_and_b32 s4, s3, 3
    s_mul_i32 s4, s4, 768
    s_lshr_b32 s3, s3, 2
    s_lshl_b32 s3, s3, 8
    s_add_u32 s3, s3, s4
    s_lshl_b32 s4, s33, 6
    s_add_u32 s3, s3, s4
    s_add_u32 s3, s3, 256
    buffer_load_dword v5, s[24:27], s3 offen lds
M_NWV_26:
    ds_write_b128 v91, v[12:15]
    v_add_u32 v6, 18832, v91
    ds_write_b128 v6, v[8:11] offset:0
    ds_write_b128 v6, v[8:11] offset:16384
    ds_write_b128 v6, v[8:11] offset:32768
    ds_write_b128 v6, v[8:11] offset:49152
    v_add_u32 v7, 84368, v91
    v_cmp_gt_u32 vcc, 39, v95
    s_mov_b64 exec, vcc
    ds_write_b128 v7, v[8:11]
    s_mov_b64 exec, -1
    v_cmp_gt_u32 vcc, 153, v95
    s_mov_b64 exec, vcc
    ds_write_b128 v91, v[12:15] offset:16384
    s_mov_b64 exec, -1
M_SU_23:
    s_waitcnt lgkmcnt(0)
    s_barrier
    s_cmp_lg_u32 s32, 15
    s_cbranch_scc1 M_POLLE_28
    s_mov_b32 s5, 0
    s_mov_b64 exec, 1
    s_and_b32 s6, s2, 7
    s_lshl_b32 s6, s6, 8
    s_add_u32 s6, s6, 21080064
M_POLL_27:
    buffer_load_dword v25, off, s[20:23], s6 sc1
    s_waitcnt vmcnt(0)
M_POLLR_30:
    v_readfirstlane_b32 s4, v25
    s_add_u32 s5, s5, 1
    s_cmp_eq_u32 s4, 131
    s_cbranch_scc1 M_POLLX_29
    s_cmp_lt_u32 s5, 1
    s_cbranch_scc1 M_POLL_27
M_POLLX_29:
    v_mov_b32 v24, 796
    ds_write_b32 v24, v25
    s_mov_b64 exec, -1
M_POLLE_28:
    s_waitcnt vmcnt(0)
    s_mov_b64 exec, s[56:57]
    s_cbranch_execz M_RK_31
    v_and_b32 v18, 1, v34
    v_lshrrev_b32 v72, 16, v34
    v_cmp_eq_u32 vcc, s84, v18
    v_min_u32 v72, 780, v72
    v_mov_b32 v35, -1
    v_and_b32 v34, 0xffe0, v34
    v_and_b32 v72, -4, v72
    s_cmp_lg_u64 vcc, exec
    s_cbranch_scc1 M_RARE_32
M_RAREB_33:
    ds_add_rtn_u32 v35, v72, v16 offset:0
M_RK_31:
    s_mov_b64 exec, s[58:59]
    s_cbranch_execz M_RK_34
    v_and_b32 v18, 1, v38
    v_lshrrev_b32 v73, 16, v38
    v_cmp_eq_u32 vcc, s84, v18
    v_min_u32 v73, 780, v73
    v_mov_b32 v39, -1
    v_and_b32 v38, 0xffe0, v38
    v_and_b32 v73, -4, v73
    s_cmp_lg_u64 vcc, exec
    s_cbranch_scc1 M_RARE_35
M_RAREB_36:
    ds_add_rtn_u32 v39, v73, v16 offset:0
M_RK_34:
    s_mov_b64 exec, s[60:61]
    s_cbranch_execz M_RK_37
    v_and_b32 v18, 1, v42
    v_lshrrev_b32 v74, 16, v42
    v_cmp_eq_u32 vcc, s84, v18
    v_min_u32 v74, 780, v74
    v_mov_b32 v43, -1
    v_and_b32 v42, 0xffe0, v42
    v_and_b32 v74, -4, v74
    s_cmp_lg_u64 vcc, exec
    s_cbranch_scc1 M_RARE_38
M_RAREB_39:
    ds_add_rtn_u32 v43, v74, v16 offset:0
M_RK_37:
    s_mov_b64 exec, s[62:63]
    s_cbranch_execz M_RK_40
    v_and_b32 v18, 1, v46
    v_lshrrev_b32 v75, 16, v46
    v_cmp_eq_u32 vcc, s84, v18
    v_min_u32 v75, 780, v75
    v_mov_b32 v47, -1
    v_and_b32 v46, 0xffe0, v46
    v_and_b32 v75, -4, v75
    s_cmp_lg_u64 vcc, exec
    s_cbranch_scc1 M_RARE_41
M_RAREB_42:
    ds_add_rtn_u32 v47, v75, v16 offset:0
M_RK_40:
    s_mov_b64 exec, s[64:65]
    s_cbranch_execz M_RK_43
    v_and_b32 v18, 1, v50
    v_lshrrev_b32 v76, 16, v50
    v_cmp_eq_u32 vcc, s84, v18
    v_min_u32 v76, 780, v76
    v_mov_b32 v51, -1
    v_and_b32 v50, 0xffe0, v50
    v_and_b32 v76, -4, v76
    s_cmp_lg_u64 vcc, exec
    s_cbranch_scc1 M_RARE_44
M_RAREB_45:
    ds_add_rtn_u32 v51, v76, v16 offset:0
M_RK_43:
    s_mov_b64 exec, s[66:67]
    s_cbranch_execz M_RK_46
    v_and_b32 v18, 1, v54
    v_lshrrev_b32 v77, 16, v54
    v_cmp_eq_u32 vcc, s84, v18
    v_min_u32 v77, 780, v77
    v_mov_b32 v55, -1
    v_and_b32 v54, 0xffe0, v54
    v_and_b32 v77, -4, v77
    s_cmp_lg_u64 vcc, exec
    s_cbranch_scc1 M_RARE_47
M_RAREB_48:
    ds_add_rtn_u32 v55, v77, v16 offset:0
M_RK_46:
    s_mov_b64 exec, s[68:69]
    s_cbranch_execz M_RK_49
    v_and_b32 v18, 1, v58
    v_lshrrev_b32 v78, 16, v58
    v_cmp_eq_u32 vcc, s84, v18
    v_min_u32 v78, 780, v78
    v_mov_b32 v59, -1
    v_and_b32 v58, 0xffe0, v58
    v_and_b32 v78, -4, v78
    s_cmp_lg_u64 vcc, exec
    s_cbranch_scc1 M_RARE_50
M_RAREB_51:
    ds_add_rtn_u32 v59, v78, v16 offset:0
M_RK_49:
    s_mov_b64 exec, s[70:71]
    s_cbranch_execz M_RK_52
    v_and_b32 v18, 1, v62
    v_lshrrev_b32 v79, 16, v62
    v_cmp_eq_u32 vcc, s84, v18
    v_min_u32 v79, 780, v79
    v_mov_b32 v63, -1
    v_and_b32 v62, 0xffe0, v62
    v_and_b32 v79, -4, v79
    s_cmp_lg_u64 vcc, exec
    s_cbranch_scc1 M_RARE_53
M_RAREB_54:
    ds_add_rtn_u32 v63, v79, v16 offset:0
M_RK_52:
    s_mov_b64 exec, s[72:73]
    s_cbranch_execz M_RK_55
    v_and_b32 v18, 1, v66
    v_lshrrev_b32 v80, 16, v66
    v_cmp_eq_u32 vcc, s84, v18
    v_min_u32 v80, 780, v80
    v_mov_b32 v67, -1
    v_and_b32 v66, 0xffe0, v66
    v_and_b32 v80, -4, v80
    s_cmp_lg_u64 vcc, exec
    s_cbranch_scc1 M_RARE_56
M_RAREB_57:
    ds_add_rtn_u32 v67, v80, v16 offset:0
M_RK_55:
    s_mov_b64 exec, s[74:75]
    s_cbranch_execz M_RK_58
    v_and_b32 v18, 1, v70
    v_lshrrev_b32 v81, 16, v70
    v_cmp_eq_u32 vcc, s84, v18
    v_min_u32 v81, 780, v81
    v_mov_b32 v71, -1
    v_and_b32 v70, 0xffe0, v70
    v_and_b32 v81, -4, v81
    s_cmp_lg_u64 vcc, exec
    s_cbranch_scc1 M_RARE_59
M_RAREB_60:
    ds_add_rtn_u32 v71, v81, v16 offset:0
M_RK_58:
    s_mov_b64 exec, -1
    s_sub_u32 s3, s101, 120
    s_cmp_lt_u32 s3, 131
    s_cbranch_scc0 M_NS3_61
    v_lshrrev_b32 v2, 2, v95
    v_and_b32 v3, 3, v94
    s_lshl_b32 s3, s35, 10
    s_lshl_b32 s4, s33, 6
    s_add_u32 s3, s3, s4
    s_add_u32 s3, s3, 256
    v_lshl_add_u32 v3, v3, 4, s3
    s_lshl_b32 s4, s32, 10
    s_add_u32 s4, s4, 91136
    v_mul_u32_u24 v4, 21846, v2
    v_lshrrev_b32 v4, 16, v4
    v_add_u32 v4, v4, v2
    s_add_u32 m0, s4, 0
    v_lshl_add_u32 v4, v4, 8, v3
    buffer_load_dwordx4 v4, s[12:15], 0 offen lds
    v_add_u32 v2, 256, v2
    v_mul_u32_u24 v4, 21846, v2
    v_lshrrev_b32 v4, 16, v4
    v_add_u32 v4, v4, v2
    s_add_u32 m0, s4, 16384
    v_lshl_add_u32 v4, v4, 8, v3
    buffer_load_dwordx4 v4, s[12:15], 0 offen lds
    v_add_u32 v2, 256, v2
    s_cmp_ge_u32 s32, 5
    s_cbranch_scc1 M_NS3_61
    v_mul_u32_u24 v4, 21846, v2
    v_lshrrev_b32 v4, 16, v4
    v_add_u32 v4, v4, v2
    s_add_u32 m0, s4, 32768
    v_lshl_add_u32 v4, v4, 8, v3
    buffer_load_dwordx4 v4, s[12:15], 0 offen lds
    v_add_u32 v2, 256, v2
M_NS3_61:
    v_mov_b32 v0, 0
    v_mov_b32 v1, 0
    v_mov_b32 v2, 0
    v_mov_b32 v3, 0
    v_mov_b32 v4, 0
    v_mov_b32 v5, 0
    v_mov_b32 v6, 0
    v_mov_b32 v7, 0
    v_mov_b32 v8, 0
    v_mov_b32 v9, 0
    v_mov_b32 v10, 0
    v_mov_b32 v11, 0
    v_mov_b32 v12, 0
    v_mov_b32 v13, 0
    v_mov_b32 v14, 0
    v_mov_b32 v15, 0
    v_mov_b32 v20, 0
    v_mov_b32 v21, 0
    v_mov_b32 v22, 0
    v_mov_b32 v23, 0
    v_mov_b32 v24, 0
    v_mov_b32 v25, 0
    v_mov_b32 v26, 0
    v_mov_b32 v27, 0
    v_mov_b32 v28, 0
    v_mov_b32 v29, 0
    v_mov_b32 v30, 0
    v_mov_b32 v31, 0
    s_waitcnt lgkmcnt(0)
    s_mov_b64 exec, s[56:57]
    s_cbranch_execz M_PL_62
    v_cmp_gt_u32 vcc, 1056, v35
    v_bfe_u32 v18, v35, 4, 5
    v_mul_u32_u24 v19, 17, v72
    s_andn2_b64 s[56:57], exec, vcc
    v_lshl_add_u32 v19, v18, 1, v19
    v_lshlrev_b32 v18, 2, v19
    s_mov_b64 exec, vcc
    ds_write_b64 v18, v[32:33] offset:18832
    ds_write_b16 v19, v34 offset:2368
M_PL_62:
    s_mov_b64 exec, s[58:59]
    s_cbranch_execz M_PL_63
    v_cmp_gt_u32 vcc, 1056, v39
    v_bfe_u32 v18, v39, 4, 5
    v_mul_u32_u24 v19, 17, v73
    s_andn2_b64 s[58:59], exec, vcc
    v_lshl_add_u32 v19, v18, 1, v19
    v_lshlrev_b32 v18, 2, v19
    s_mov_b64 exec, vcc
    ds_write_b64 v18, v[36:37] offset:18832
    ds_write_b16 v19, v38 offset:2368
M_PL_63:
    s_mov_b64 exec, s[60:61]
    s_cbranch_execz M_PL_64
    v_cmp_gt_u32 vcc, 1056, v43
    v_bfe_u32 v18, v43, 4, 5
    v_mul_u32_u24 v19, 17, v74
    s_andn2_b64 s[60:61], exec, vcc
    v_lshl_add_u32 v19, v18, 1, v19
    v_lshlrev_b32 v18, 2, v19
    s_mov_b64 exec, vcc
    ds_write_b64 v18, v[40:41] offset:18832
    ds_write_b16 v19, v42 offset:2368
M_PL_64:
    s_mov_b64 exec, s[62:63]
    s_cbranch_execz M_PL_65
    v_cmp_gt_u32 vcc, 1056, v47
    v_bfe_u32 v18, v47, 4, 5
    v_mul_u32_u24 v19, 17, v75
    s_andn2_b64 s[62:63], exec, vcc
    v_lshl_add_u32 v19, v18, 1, v19
    v_lshlrev_b32 v18, 2, v19
    s_mov_b64 exec, vcc
    ds_write_b64 v18, v[44:45] offset:18832
    ds_write_b16 v19, v46 offset:2368
M_PL_65:
    s_mov_b64 exec, s[64:65]
    s_cbranch_execz M_PL_66
    v_cmp_gt_u32 vcc, 1056, v51
    v_bfe_u32 v18, v51, 4, 5
    v_mul_u32_u24 v19, 17, v76
    s_andn2_b64 s[64:65], exec, vcc
    v_lshl_add_u32 v19, v18, 1, v19
    v_lshlrev_b32 v18, 2, v19
    s_mov_b64 exec, vcc
    ds_write_b64 v18, v[48:49] offset:18832
    ds_write_b16 v19, v50 offset:2368
M_PL_66:
    s_mov_b64 exec, s[66:67]
    s_cbranch_execz M_PL_67
    v_cmp_gt_u32 vcc, 1056, v55
    v_bfe_u32 v18, v55, 4, 5
    v_mul_u32_u24 v19, 17, v77
    s_andn2_b64 s[66:67], exec, vcc
    v_lshl_add_u32 v19, v18, 1, v19
    v_lshlrev_b32 v18, 2, v19
    s_mov_b64 exec, vcc
    ds_write_b64 v18, v[52:53] offset:18832
    ds_write_b16 v19, v54 offset:2368
M_PL_67:
    s_mov_b64 exec, s[68:69]
    s_cbranch_execz M_PL_68
    v_cmp_gt_u32 vcc, 1056, v59
    v_bfe_u32 v18, v59, 4, 5
    v_mul_u32_u24 v19, 17, v78
    s_andn2_b64 s[68:69], exec, vcc
    v_lshl_add_u32 v19, v18, 1, v19
    v_lshlrev_b32 v18, 2, v19
    s_mov_b64 exec, vcc
    ds_write_b64 v18, v[56:57] offset:18832
    ds_write_b16 v19, v58 offset:2368
M_PL_68:
    s_mov_b64 exec, s[70:71]
    s_cbranch_execz M_PL_69
    v_cmp_gt_u32 vcc, 1056, v63
    v_bfe_u32 v18, v63, 4, 5
    v_mul_u32_u24 v19, 17, v79
    s_andn2_b64 s[70:71], exec, vcc
    v_lshl_add_u32 v19, v18, 1, v19
    v_lshlrev_b32 v18, 2, v19
    s_mov_b64 exec, vcc
    ds_write_b64 v18, v[60:61] offset:18832
    ds_write_b16 v19, v62 offset:2368
M_PL_69:
    s_mov_b64 exec, s[72:73]
    s_cbranch_execz M_PL_70
    v_cmp_gt_u32 vcc, 1056, v67
    v_bfe_u32 v18, v67, 4, 5
    v_mul_u32_u24 v19, 17, v80
    s_andn2_b64 s[72:73], exec, vcc
    v_lshl_add_u32 v19, v18, 1, v19
    v_lshlrev_b32 v18, 2, v19
    s_mov_b64 exec, vcc
    ds_write_b64 v18, v[64:65] offset:18832
    ds_write_b16 v19, v66 offset:2368
M_PL_70:
    s_mov_b64 exec, s[74:75]
    s_cbranch_execz M_PL_71
    v_cmp_gt_u32 vcc, 1056, v71
    v_bfe_u32 v18, v71, 4, 5
    v_mul_u32_u24 v19, 17, v81
    s_andn2_b64 s[74:75], exec, vcc
    v_lshl_add_u32 v19, v18, 1, v19
    v_lshlrev_b32 v18, 2, v19
    s_mov_b64 exec, vcc
    ds_write_b64 v18, v[68:69] offset:18832
    ds_write_b16 v19, v70 offset:2368
M_PL_71:
    s_mov_b64 exec, -1
    s_waitcnt lgkmcnt(0)
    s_barrier
    s_lshl_b32 s3, s32, 3
    v_mov_b32 v84, s3
    v_mov_b32 v85, 796
    ds_read_b32 v84, v84 offset:0
    ds_read_b32 v85, v85
    s_mul_i32 s4, s32, 136
    s_lshl_b32 s5, s4, 2
    v_add_u32 v86, s5, v122
    ds_read_u16 v83, v86 offset:18838
    v_add_u32 v86, s4, v120
    ds_read_b32 v116, v86 offset:2368
    v_add_u32 v86, s4, v121
    ds_read_b32 v117, v86 offset:2368
    v_mov_b32 v16, 0
    v_mov_b32 v17, 0
    v_mov_b32 v18, 0
    v_mov_b32 v19, 0
    s_waitcnt lgkmcnt(0)
    v_readfirstlane_b32 s47, v84
    v_readfirstlane_b32 s79, v85
    v_lshlrev_b32 v83, 8, v83
    v_add_u32_sdwa v84, v117, v124 dst_sel:DWORD dst_unused:UNUSED_PAD src0_sel:WORD_0 src1_sel:DWORD
    v_add_u32_sdwa v85, v117, v124 dst_sel:DWORD dst_unused:UNUSED_PAD src0_sel:WORD_1 src1_sel:DWORD
    v_add_u32_sdwa v86, v116, v123 dst_sel:DWORD dst_unused:UNUSED_PAD src0_sel:WORD_0 src1_sel:DWORD
    v_add_u32_sdwa v87, v116, v123 dst_sel:DWORD dst_unused:UNUSED_PAD src0_sel:WORD_1 src1_sel:DWORD
    ds_read_b64 v[112:113], v84
    ds_read_b64 v[114:115], v85
    ds_read_b64_tr_b16 v[108:109], v86
    ds_read_b64_tr_b16 v[110:111], v87
    s_sub_u32 s3, s32, 4
    s_cmp_lt_u32 s3, 8
    s_cselect_b32 s78, s79, 0
    s_cmp_eq_u32 s78, 131
    s_cselect_b32 s78, 1, 0
    s_cmp_lg_u32 s78, 0
    s_cbranch_scc0 M_FG_72
    s_waitcnt vmcnt(0)
    s_cmp_le_u32 s47, 0
    s_cbranch_scc1 M_FG_72
    v_add_u32_dpp v116, v83, v125 row_newbcast:0 row_mask:0xf bank_mask:0xf
    buffer_load_dwordx4 v[0:3], v116, s[8:11], 0 offen
    s_cmp_le_u32 s47, 132
    s_cbranch_scc1 M_FG_72
    v_add_u32_dpp v117, v83, v125 row_newbcast:1 row_mask:0xf bank_mask:0xf
    buffer_load_dwordx4 v[4:7], v117, s[8:11], 0 offen
    s_cmp_le_u32 s47, 264
    s_cbranch_scc1 M_FG_72
    v_add_u32_dpp v116, v83, v125 row_newbcast:2 row_mask:0xf bank_mask:0xf
    buffer_load_dwordx4 v[8:11], v116, s[8:11], 0 offen
    s_cmp_le_u32 s47, 396
    s_cbranch_scc1 M_FG_72
    v_add_u32_dpp v117, v83, v125 row_newbcast:3 row_mask:0xf bank_mask:0xf
    buffer_load_dwordx4 v[12:15], v117, s[8:11], 0 offen
    s_cmp_le_u32 s47, 528
    s_cbranch_scc1 M_FG_72
    v_add_u32_dpp v116, v83, v125 row_newbcast:4 row_mask:0xf bank_mask:0xf
    buffer_load_dwordx4 v[16:19], v116, s[8:11], 0 offen
    s_cmp_le_u32 s47, 660
    s_cbranch_scc1 M_FG_72
    v_add_u32_dpp v117, v83, v125 row_newbcast:5 row_mask:0xf bank_mask:0xf
    buffer_load_dwordx4 v[20:23], v117, s[8:11], 0 offen
    s_cmp_le_u32 s47, 792
    s_cbranch_scc1 M_FG_72
    v_add_u32_dpp v116, v83, v125 row_newbcast:6 row_mask:0xf bank_mask:0xf
    buffer_load_dwordx4 v[24:27], v116, s[8:11], 0 offen
    s_cmp_le_u32 s47, 924
    s_cbranch_scc1 M_FG_72
    v_add_u32_dpp v117, v83, v125 row_newbcast:7 row_mask:0xf bank_mask:0xf
    buffer_load_dwordx4 v[28:31], v117, s[8:11], 0 offen
M_FG_72:
    s_cmp_ge_u32 s32, 4
    s_cbranch_scc1 M_NOALLOC
    v_lshlrev_b32 v82, 2, v95
    v_cmp_gt_u32 vcc, 196, v95
    s_mov_b64 exec, vcc
    ds_read_b32 v84, v82 offset:0
    v_mov_b32 v85, 46
    v_mov_b32 v86, 788
    v_mov_b32 v87, 1
    s_sub_u32 s3, 12500, s35
    v_cmp_gt_u32 vcc, s3, v95
    v_mov_b32 v88, 1024
    v_mov_b32 v117, 1280
    v_cndmask_b32 v88, v88, v117, vcc
    v_or_b32 v88, v88, v95
    s_waitcnt lgkmcnt(0)
    v_min_u32 v84, 2112, v84
    v_mul_u32_u24 v84, 1986, v84
    v_lshrrev_b32 v84, 16, v84
    v_cmp_lt_u32 vcc, 32, v84
    s_and_saveexec_b64 s[0:1], vcc
    ds_add_rtn_u32 v85, v86, v87
    s_mov_b64 exec, s[0:1]
    s_cmp_lt_u32 s34, 62
    s_cselect_b32 s4, 53, 49
    s_sub_u32 s5, 98, s4
    s_add_u32 s3, s33, s34
    s_bitcmp0_b32 s3, 0
    s_cselect_b32 s5, s4, s5
    s_cselect_b32 s4, 0, s4
    s_lshr_b32 s3, s33, 1
    s_mul_i32 s3, s3, 98
    s_add_u32 s3, s3, s4
    v_subrev_u32 v117, s3, v95
    s_waitcnt lgkmcnt(0)
    v_cmp_gt_u32 vcc, 46, v85
    v_add_u32 v85, 196, v85
    v_min_u32 v86, 64, v84
    v_lshl_or_b32 v86, v85, 7, v86
    v_min_u32 v84, 32, v84
    v_cndmask_b32 v84, v84, v86, vcc
    v_lshl_or_b32 v84, v88, 16, v84
    ds_write_b32 v82, v84 offset:800
    v_cmp_gt_u32 vcc, s5, v117
    v_or_b32 v84, 33554432, v84
    v_lshlrev_b32 v117, 3, v117
    s_and_b64 exec, exec, vcc
    ds_write_b32 v117, v84 offset:1584
    s_mov_b64 exec, -1
    s_waitcnt lgkmcnt(0)
M_NOALLOC:
    s_barrier
    s_waitcnt lgkmcnt(0)
    s_lshl_b32 s3, s32, 3
    v_mov_b32 v85, s3
    ds_read_b64 v[86:87], v85 offset:800
    v_lshlrev_b32 v88, 2, v94
    v_add_u32 v88, 89088, v88
    ds_read2st64_b32 v[100:101], v88 offset0:0 offset1:1
    ds_read2st64_b32 v[102:103], v88 offset0:2 offset1:3
    ds_read2st64_b32 v[96:97], v88 offset0:4 offset1:5
    ds_read2st64_b32 v[98:99], v88 offset0:6 offset1:7
    s_movk_i32 s6, 68
    s_mov_b32 s7, 0
    s_mov_b64 exec, s[56:57]
    s_cbranch_execz M_P1_73
    ds_read_b32 v72, v72 offset:800
M_P1_73:
    s_mov_b64 exec, s[58:59]
    s_cbranch_execz M_P1_74
    ds_read_b32 v73, v73 offset:800
M_P1_74:
    s_mov_b64 exec, s[60:61]
    s_cbranch_execz M_P1_75
    ds_read_b32 v74, v74 offset:800
M_P1_75:
    s_mov_b64 exec, s[62:63]
    s_cbranch_execz M_P1_76
    ds_read_b32 v75, v75 offset:800
M_P1_76:
    s_mov_b64 exec, s[64:65]
    s_cbranch_execz M_P1_77
    ds_read_b32 v76, v76 offset:800
M_P1_77:
    s_mov_b64 exec, s[66:67]
    s_cbranch_execz M_P1_78
    ds_read_b32 v77, v77 offset:800
M_P1_78:
    s_mov_b64 exec, s[68:69]
    s_cbranch_execz M_P1_79
    ds_read_b32 v78, v78 offset:800
M_P1_79:
    s_mov_b64 exec, s[70:71]
    s_cbranch_execz M_P1_80
    ds_read_b32 v79, v79 offset:800
M_P1_80:
    s_mov_b64 exec, s[72:73]
    s_cbranch_execz M_P1_81
    ds_read_b32 v80, v80 offset:800
M_P1_81:
    s_mov_b64 exec, s[74:75]
    s_cbranch_execz M_P1_82
    ds_read_b32 v81, v81 offset:800
M_P1_82:
    s_mov_b64 exec, -1
    s_waitcnt lgkmcnt(0)
    s_mov_b64 exec, s[56:57]
    s_cbranch_execz M_P2_83
    v_and_b32 v84, 0x7f, v72
    v_mul_u32_u24 v84, 33, v84
    v_cmp_lt_u32 vcc, v35, v84
    v_subrev_u32 v82, 1056, v35
    v_bfe_u32 v82, v82, 4, 5
    v_bfe_u32 v84, v72, 7, 9
    s_andn2_b64 s[56:57], exec, vcc
    v_cmp_eq_u32 s[0:1], -1, v35
    s_cmp_lg_u64 s[0:1], 0
    s_cselect_b32 s3, 4, 0
    s_or_b32 s7, s7, s3
    s_andn2_b64 s[0:1], s[56:57], s[0:1]
    s_cselect_b32 s3, 1, 0
    s_or_b32 s7, s7, s3
    v_mul_u32_u24 v84, s6, v84
    v_lshl_add_u32 v84, v82, 1, v84
    v_lshlrev_b32 v82, 2, v84
    s_mov_b64 exec, vcc
    ds_write_b64 v82, v[32:33] offset:18832
    ds_write_b16 v84, v34 offset:2368
M_P2_83:
    s_mov_b64 exec, s[58:59]
    s_cbranch_execz M_P2_84
    v_and_b32 v84, 0x7f, v73
    v_mul_u32_u24 v84, 33, v84
    v_cmp_lt_u32 vcc, v39, v84
    v_subrev_u32 v82, 1056, v39
    v_bfe_u32 v82, v82, 4, 5
    v_bfe_u32 v84, v73, 7, 9
    s_andn2_b64 s[58:59], exec, vcc
    v_cmp_eq_u32 s[0:1], -1, v39
    s_cmp_lg_u64 s[0:1], 0
    s_cselect_b32 s3, 4, 0
    s_or_b32 s7, s7, s3
    s_andn2_b64 s[0:1], s[58:59], s[0:1]
    s_cselect_b32 s3, 1, 0
    s_or_b32 s7, s7, s3
    v_mul_u32_u24 v84, s6, v84
    v_lshl_add_u32 v84, v82, 1, v84
    v_lshlrev_b32 v82, 2, v84
    s_mov_b64 exec, vcc
    ds_write_b64 v82, v[36:37] offset:18832
    ds_write_b16 v84, v38 offset:2368
M_P2_84:
    s_mov_b64 exec, s[60:61]
    s_cbranch_execz M_P2_85
    v_and_b32 v84, 0x7f, v74
    v_mul_u32_u24 v84, 33, v84
    v_cmp_lt_u32 vcc, v43, v84
    v_subrev_u32 v82, 1056, v43
    v_bfe_u32 v82, v82, 4, 5
    v_bfe_u32 v84, v74, 7, 9
    s_andn2_b64 s[60:61], exec, vcc
    v_cmp_eq_u32 s[0:1], -1, v43
    s_cmp_lg_u64 s[0:1], 0
    s_cselect_b32 s3, 4, 0
    s_or_b32 s7, s7, s3
    s_andn2_b64 s[0:1], s[60:61], s[0:1]
    s_cselect_b32 s3, 1, 0
    s_or_b32 s7, s7, s3
    v_mul_u32_u24 v84, s6, v84
    v_lshl_add_u32 v84, v82, 1, v84
    v_lshlrev_b32 v82, 2, v84
    s_mov_b64 exec, vcc
    ds_write_b64 v82, v[40:41] offset:18832
    ds_write_b16 v84, v42 offset:2368
M_P2_85:
    s_mov_b64 exec, s[62:63]
    s_cbranch_execz M_P2_86
    v_and_b32 v84, 0x7f, v75
    v_mul_u32_u24 v84, 33, v84
    v_cmp_lt_u32 vcc, v47, v84
    v_subrev_u32 v82, 1056, v47
    v_bfe_u32 v82, v82, 4, 5
    v_bfe_u32 v84, v75, 7, 9
    s_andn2_b64 s[62:63], exec, vcc
    v_cmp_eq_u32 s[0:1], -1, v47
    s_cmp_lg_u64 s[0:1], 0
    s_cselect_b32 s3, 4, 0
    s_or_b32 s7, s7, s3
    s_andn2_b64 s[0:1], s[62:63], s[0:1]
    s_cselect_b32 s3, 1, 0
    s_or_b32 s7, s7, s3
    v_mul_u32_u24 v84, s6, v84
    v_lshl_add_u32 v84, v82, 1, v84
    v_lshlrev_b32 v82, 2, v84
    s_mov_b64 exec, vcc
    ds_write_b64 v82, v[44:45] offset:18832
    ds_write_b16 v84, v46 offset:2368
M_P2_86:
    s_mov_b64 exec, s[64:65]
    s_cbranch_execz M_P2_87
    v_and_b32 v84, 0x7f, v76
    v_mul_u32_u24 v84, 33, v84
    v_cmp_lt_u32 vcc, v51, v84
    v_subrev_u32 v82, 1056, v51
    v_bfe_u32 v82, v82, 4, 5
    v_bfe_u32 v84, v76, 7, 9
    s_andn2_b64 s[64:65], exec, vcc
    v_cmp_eq_u32 s[0:1], -1, v51
    s_cmp_lg_u64 s[0:1], 0
    s_cselect_b32 s3, 4, 0
    s_or_b32 s7, s7, s3
    s_andn2_b64 s[0:1], s[64:65], s[0:1]
    s_cselect_b32 s3, 1, 0
    s_or_b32 s7, s7, s3
    v_mul_u32_u24 v84, s6, v84
    v_lshl_add_u32 v84, v82, 1, v84
    v_lshlrev_b32 v82, 2, v84
    s_mov_b64 exec, vcc
    ds_write_b64 v82, v[48:49] offset:18832
    ds_write_b16 v84, v50 offset:2368
M_P2_87:
    s_mov_b64 exec, s[66:67]
    s_cbranch_execz M_P2_88
    v_and_b32 v84, 0x7f, v77
    v_mul_u32_u24 v84, 33, v84
    v_cmp_lt_u32 vcc, v55, v84
    v_subrev_u32 v82, 1056, v55
    v_bfe_u32 v82, v82, 4, 5
    v_bfe_u32 v84, v77, 7, 9
    s_andn2_b64 s[66:67], exec, vcc
    v_cmp_eq_u32 s[0:1], -1, v55
    s_cmp_lg_u64 s[0:1], 0
    s_cselect_b32 s3, 4, 0
    s_or_b32 s7, s7, s3
    s_andn2_b64 s[0:1], s[66:67], s[0:1]
    s_cselect_b32 s3, 1, 0
    s_or_b32 s7, s7, s3
    v_mul_u32_u24 v84, s6, v84
    v_lshl_add_u32 v84, v82, 1, v84
    v_lshlrev_b32 v82, 2, v84
    s_mov_b64 exec, vcc
    ds_write_b64 v82, v[52:53] offset:18832
    ds_write_b16 v84, v54 offset:2368
M_P2_88:
    s_mov_b64 exec, s[68:69]
    s_cbranch_execz M_P2_89
    v_and_b32 v84, 0x7f, v78
    v_mul_u32_u24 v84, 33, v84
    v_cmp_lt_u32 vcc, v59, v84
    v_subrev_u32 v82, 1056, v59
    v_bfe_u32 v82, v82, 4, 5
    v_bfe_u32 v84, v78, 7, 9
    s_andn2_b64 s[68:69], exec, vcc
    v_cmp_eq_u32 s[0:1], -1, v59
    s_cmp_lg_u64 s[0:1], 0
    s_cselect_b32 s3, 4, 0
    s_or_b32 s7, s7, s3
    s_andn2_b64 s[0:1], s[68:69], s[0:1]
    s_cselect_b32 s3, 1, 0
    s_or_b32 s7, s7, s3
    v_mul_u32_u24 v84, s6, v84
    v_lshl_add_u32 v84, v82, 1, v84
    v_lshlrev_b32 v82, 2, v84
    s_mov_b64 exec, vcc
    ds_write_b64 v82, v[56:57] offset:18832
    ds_write_b16 v84, v58 offset:2368
M_P2_89:
    s_mov_b64 exec, s[70:71]
    s_cbranch_execz M_P2_90
    v_and_b32 v84, 0x7f, v79
    v_mul_u32_u24 v84, 33, v84
    v_cmp_lt_u32 vcc, v63, v84
    v_subrev_u32 v82, 1056, v63
    v_bfe_u32 v82, v82, 4, 5
    v_bfe_u32 v84, v79, 7, 9
    s_andn2_b64 s[70:71], exec, vcc
    v_cmp_eq_u32 s[0:1], -1, v63
    s_cmp_lg_u64 s[0:1], 0
    s_cselect_b32 s3, 4, 0
    s_or_b32 s7, s7, s3
    s_andn2_b64 s[0:1], s[70:71], s[0:1]
    s_cselect_b32 s3, 1, 0
    s_or_b32 s7, s7, s3
    v_mul_u32_u24 v84, s6, v84
    v_lshl_add_u32 v84, v82, 1, v84
    v_lshlrev_b32 v82, 2, v84
    s_mov_b64 exec, vcc
    ds_write_b64 v82, v[60:61] offset:18832
    ds_write_b16 v84, v62 offset:2368
M_P2_90:
    s_mov_b64 exec, s[72:73]
    s_cbranch_execz M_P2_91
    v_and_b32 v84, 0x7f, v80
    v_mul_u32_u24 v84, 33, v84
    v_cmp_lt_u32 vcc, v67, v84
    v_subrev_u32 v82, 1056, v67
    v_bfe_u32 v82, v82, 4, 5
    v_bfe_u32 v84, v80, 7, 9
    s_andn2_b64 s[72:73], exec, vcc
    v_cmp_eq_u32 s[0:1], -1, v67
    s_cmp_lg_u64 s[0:1], 0
    s_cselect_b32 s3, 4, 0
    s_or_b32 s7, s7, s3
    s_andn2_b64 s[0:1], s[72:73], s[0:1]
    s_cselect_b32 s3, 1, 0
    s_or_b32 s7, s7, s3
    v_mul_u32_u24 v84, s6, v84
    v_lshl_add_u32 v84, v82, 1, v84
    v_lshlrev_b32 v82, 2, v84
    s_mov_b64 exec, vcc
    ds_write_b64 v82, v[64:65] offset:18832
    ds_write_b16 v84, v66 offset:2368
M_P2_91:
    s_mov_b64 exec, s[74:75]
    s_cbranch_execz M_P2_92
    v_and_b32 v84, 0x7f, v81
    v_mul_u32_u24 v84, 33, v84
    v_cmp_lt_u32 vcc, v71, v84
    v_subrev_u32 v82, 1056, v71
    v_bfe_u32 v82, v82, 4, 5
    v_bfe_u32 v84, v81, 7, 9
    s_andn2_b64 s[74:75], exec, vcc
    v_cmp_eq_u32 s[0:1], -1, v71
    s_cmp_lg_u64 s[0:1], 0
    s_cselect_b32 s3, 4, 0
    s_or_b32 s7, s7, s3
    s_andn2_b64 s[0:1], s[74:75], s[0:1]
    s_cselect_b32 s3, 1, 0
    s_or_b32 s7, s7, s3
    v_mul_u32_u24 v84, s6, v84
    v_lshl_add_u32 v84, v82, 1, v84
    v_lshlrev_b32 v82, 2, v84
    s_mov_b64 exec, vcc
    ds_write_b64 v82, v[68:69] offset:18832
    ds_write_b16 v84, v70 offset:2368
M_P2_92:
    s_mov_b64 exec, -1
    v_perm_b32 v104, v97, v96, s41
    v_perm_b32 v106, v97, v96, s42
    v_perm_b32 v105, v99, v98, s41
    v_perm_b32 v107, v99, v98, s42
    v_lshlrev_b32 v96, 16, v100
    v_and_b32 v100, 0xffff0000, v100
    v_lshlrev_b32 v97, 16, v101
    v_and_b32 v101, 0xffff0000, v101
    v_lshlrev_b32 v98, 16, v102
    v_and_b32 v102, 0xffff0000, v102
    v_lshlrev_b32 v99, 16, v103
    v_and_b32 v103, 0xffff0000, v103
    v_readfirstlane_b32 s76, v86
    v_readfirstlane_b32 s77, v87
    s_or_b32 s3, s7, s40
    v_mov_b32 v84, 792
    s_cbranch_scc0 M_NOFLAG
    v_mov_b32 v82, s3
    ds_or_b32 v84, v82
M_NOFLAG:
    s_cmp_eq_u32 s79, 131
    s_cbranch_scc1 M_TOK
    s_cmp_lg_u32 s32, 15
    s_cbranch_scc1 M_POLLE_94
    s_mov_b32 s5, 0
    s_mov_b64 exec, 1
    s_and_b32 s6, s2, 7
    s_lshl_b32 s6, s6, 8
    s_add_u32 s6, s6, 21080064
M_POLL_93:
    buffer_load_dword v82, off, s[20:23], s6 sc1
    s_waitcnt vmcnt(0)
M_POLLR_96:
    v_readfirstlane_b32 s4, v82
    s_add_u32 s5, s5, 1
    s_cmp_gt_u32 s5, 4000000
    s_cselect_b32 s4, 131, s4
    s_cmp_eq_u32 s4, 131
    s_cbranch_scc1 M_POLLX_95
    s_sleep 1
    s_branch M_POLL_93
M_POLLX_95:
    s_mov_b64 exec, -1
M_POLLE_94:
M_TOK:
    s_cmp_lg_u32 s78, 0
    s_cbranch_scc1 M_TOK2
    s_waitcnt vmcnt(0)
M_TOK2:
    s_waitcnt lgkmcnt(0)
    s_barrier
    ds_read_b32 v82, v84
    s_cmp_lg_u32 s78, 0
    s_cbranch_scc1 M_FG_97
    s_cmp_le_u32 s47, 0
    s_cbranch_scc1 M_FG_97
    v_add_u32_dpp v116, v83, v125 row_newbcast:0 row_mask:0xf bank_mask:0xf
    buffer_load_dwordx4 v[0:3], v116, s[8:11], 0 offen
    s_cmp_le_u32 s47, 132
    s_cbranch_scc1 M_FG_97
    v_add_u32_dpp v117, v83, v125 row_newbcast:1 row_mask:0xf bank_mask:0xf
    buffer_load_dwordx4 v[4:7], v117, s[8:11], 0 offen
    s_cmp_le_u32 s47, 264
    s_cbranch_scc1 M_FG_97
    v_add_u32_dpp v116, v83, v125 row_newbcast:2 row_mask:0xf bank_mask:0xf
    buffer_load_dwordx4 v[8:11], v116, s[8:11], 0 offen
    s_cmp_le_u32 s47, 396
    s_cbranch_scc1 M_FG_97
    v_add_u32_dpp v117, v83, v125 row_newbcast:3 row_mask:0xf bank_mask:0xf
    buffer_load_dwordx4 v[12:15], v117, s[8:11], 0 offen
    s_cmp_le_u32 s47, 528
    s_cbranch_scc1 M_FG_97
    v_add_u32_dpp v116, v83, v125 row_newbcast:4 row_mask:0xf bank_mask:0xf
    buffer_load_dwordx4 v[16:19], v116, s[8:11], 0 offen
    s_cmp_le_u32 s47, 660
    s_cbranch_scc1 M_FG_97
    v_add_u32_dpp v117, v83, v125 row_newbcast:5 row_mask:0xf bank_mask:0xf
    buffer_load_dwordx4 v[20:23], v117, s[8:11], 0 offen
    s_cmp_le_u32 s47, 792
    s_cbranch_scc1 M_FG_97
    v_add_u32_dpp v116, v83, v125 row_newbcast:6 row_mask:0xf bank_mask:0xf
    buffer_load_dwordx4 v[24:27], v116, s[8:11], 0 offen
    s_cmp_le_u32 s47, 924
    s_cbranch_scc1 M_FG_97
    v_add_u32_dpp v117, v83, v125 row_newbcast:7 row_mask:0xf bank_mask:0xf
    buffer_load_dwordx4 v[28:31], v117, s[8:11], 0 offen
M_FG_97:
    v_mfma_f32_16x16x16_bf16 v[64:67], v[112:113], v[104:105], 0
    v_mfma_f32_16x16x16_bf16 v[68:71], v[112:113], v[106:107], 0
    v_mfma_f32_16x16x16_bf16 v[72:75], v[114:115], v[104:105], 0
    v_mfma_f32_16x16x16_bf16 v[76:79], v[114:115], v[106:107], 0
    s_mul_i32 s5, s32, 544
    v_lshl_add_u32 v85, v120, 2, s5
    ds_read_b64_tr_b16 v[112:113], v85 offset:18832
    ds_read_b64_tr_b16 v[114:115], v85 offset:18840
    v_mov_b32 v33, 0
    v_mov_b32 v34, 0
    v_mov_b32 v35, 0
    v_mov_b32 v37, 0
    v_mov_b32 v38, 0
    v_mov_b32 v39, 0
    v_mov_b32 v41, 0
    v_mov_b32 v42, 0
    v_mov_b32 v43, 0
    v_mov_b32 v45, 0
    v_mov_b32 v46, 0
    v_mov_b32 v47, 0
    v_mov_b32 v49, 0
    v_mov_b32 v50, 0
    v_mov_b32 v51, 0
    v_mov_b32 v53, 0
    v_mov_b32 v54, 0
    v_mov_b32 v55, 0
    v_mov_b32 v57, 0
    v_mov_b32 v58, 0
    v_mov_b32 v59, 0
    v_mov_b32 v61, 0
    v_mov_b32 v62, 0
    v_mov_b32 v63, 0
    s_mov_b32 s54, 0
    s_mov_b32 s78, 0
    s_mov_b32 s79, 0
    s_waitcnt lgkmcnt(2)
    v_readfirstlane_b32 s39, v82
    s_xor_b32 s55, s38, 1
    s_or_b32 s55, s55, s39
    s_cmp_lg_u32 s54, 0
    s_cbranch_scc1 M_ND2_98
    s_bfe_u32 s52, s76, 0x80010
    s_mov_b32 s50, s52
    s_and_b32 s51, s76, 0x7f
    s_lshr_b32 s53, s76, 24
    s_cmp_gt_u32 s51, 32
    s_cselect_b32 s54, s76, 0
    s_cselect_b32 s4, 8, 24
    s_or_b32 s53, s53, s4
    s_min_u32 s51, s51, 32
    s_mov_b32 s76, s77
    s_mov_b32 s77, 0
    s_or_b32 s4, s76, s79
    s_cbranch_scc1 M_NDE_99
    s_mov_b32 s78, 1
    s_mov_b32 exec_lo, 0
    s_mov_b32 exec_hi, 1
    ds_add_rtn_u32 v87, v125, v120 offset:784
    s_mov_b64 exec, -1
    s_branch M_NDE_99
M_ND2_98:
    s_bfe_u32 s50, s54, 0x90007
    s_and_b32 s51, s54, 0x7f
    s_sub_u32 s51, s51, 32
    s_lshr_b32 s53, s54, 24
    s_or_b32 s53, s53, 16
    s_mov_b32 s54, 0
M_NDE_99:
    s_mov_b32 s43, s47
    s_mov_b64 s[44:45], s[48:49]
    s_mov_b64 s[46:47], s[50:51]
    s_mov_b64 s[48:49], s[52:53]
    s_cmp_lg_u32 s54, 0
    s_cbranch_scc1 M_ND2_101
    s_bfe_u32 s52, s76, 0x80010
    s_mov_b32 s50, s52
    s_and_b32 s51, s76, 0x7f
    s_lshr_b32 s53, s76, 24
    s_cmp_gt_u32 s51, 32
    s_cselect_b32 s54, s76, 0
    s_cselect_b32 s4, 8, 24
    s_or_b32 s53, s53, s4
    s_min_u32 s51, s51, 32
    s_mov_b32 s76, s77
    s_mov_b32 s77, 0
    s_or_b32 s4, s76, s79
    s_cbranch_scc1 M_NDE_102
    s_mov_b32 s78, 1
    s_mov_b32 exec_lo, 0
    s_mov_b32 exec_hi, 1
    ds_add_rtn_u32 v87, v125, v120 offset:784
    s_mov_b64 exec, -1
    s_branch M_NDE_102
M_ND2_101:
    s_bfe_u32 s50, s54, 0x90007
    s_and_b32 s51, s54, 0x7f
    s_sub_u32 s51, s51, 32
    s_lshr_b32 s53, s54, 24
    s_or_b32 s53, s53, 16
    s_mov_b32 s54, 0
M_NDE_102:
    s_mul_i32 s4, s50, 68
    s_lshl_b32 s5, s4, 2
    v_add_u32 v91, s4, v120
    ds_read_b32 v116, v91 offset:2368
    v_add_u32 v95, s5, v122
    ds_read_u16 v83, v95 offset:18838
    v_add_u32 v91, s4, v121
    ds_read_b32 v117, v91 offset:2368
    s_mov_b32 s43, s47
    s_mov_b64 s[44:45], s[48:49]
    s_mov_b64 s[46:47], s[50:51]
    s_mov_b64 s[48:49], s[52:53]
    s_branch VA_TOP0
VA_TOP0:
    s_waitcnt vmcnt(0)
VA_TOP:
    s_setprio 1
    s_cmp_eq_u32 s78, 0
    s_cbranch_scc1 M_CT_104
    s_waitcnt lgkmcnt(0)
    s_mov_b32 exec_lo, 0
    s_mov_b32 exec_hi, 1
    ds_read_b32 v91, v87 offset:928
    ds_read_b32 v95, v87 offset:932
    s_mov_b64 exec, -1
M_CT_104:
    s_waitcnt vmcnt(1) lgkmcnt(0)
    v_lshlrev_b32 v83, 8, v83
    s_cmp_eq_u32 s78, 0
    s_cbranch_scc1 M_CM_105
    v_readlane_b32 s76, v91, 32
    v_readlane_b32 s77, v95, 32
    s_mov_b32 s78, 0
    s_cmp_eq_u32 s76, 0
    s_cselect_b32 s79, 1, 0
M_CM_105:
    v_mul_f32 v68, v68, v3
    v_perm_b32 v32, v4, v0, s41
    v_mul_f32 v69, v69, v7
    v_perm_b32 v36, v4, v0, s42
    v_lshlrev_b32 v3, 16, v3
    v_lshlrev_b32 v7, 16, v7
    v_perm_b32 v40, v5, v1, s41
    v_mul_f32 v64, v64, v3
    v_perm_b32 v44, v5, v1, s42
    v_mul_f32 v65, v65, v7
    v_perm_b32 v48, v6, v2, s41
    v_cvt_pk_bf16_f32 v60, v68, v69
    v_perm_b32 v52, v6, v2, s42
    v_cvt_pk_bf16_f32 v56, v64, v65
V_NP_106:
    s_cmp_le_u32 s47, 0
    s_cbranch_scc1 M_G1_107
    v_add_u32_dpp v91, v83, v125 row_newbcast:0 row_mask:0xf bank_mask:0xf
    buffer_load_dwordx4 v[0:3], v91, s[8:11], 0 offen
M_G1_107:
    s_cmp_le_u32 s47, 4
    s_cbranch_scc1 M_G1_108
    v_add_u32_dpp v95, v83, v125 row_newbcast:1 row_mask:0xf bank_mask:0xf
    buffer_load_dwordx4 v[4:7], v95, s[8:11], 0 offen
M_G1_108:
    s_cmp_le_u32 s43, 8
    s_cbranch_scc1 V_NP_109
    v_mul_f32 v70, v70, v11
    v_perm_b32 v33, v12, v8, s41
    v_mul_f32 v71, v71, v15
    v_perm_b32 v37, v12, v8, s42
    v_lshlrev_b32 v11, 16, v11
    v_lshlrev_b32 v15, 16, v15
    v_perm_b32 v41, v13, v9, s41
    v_mul_f32 v66, v66, v11
    v_perm_b32 v45, v13, v9, s42
    v_mul_f32 v67, v67, v15
    v_perm_b32 v49, v14, v10, s41
    v_cvt_pk_bf16_f32 v61, v70, v71
    v_perm_b32 v53, v14, v10, s42
    v_cvt_pk_bf16_f32 v57, v66, v67
V_NP_109:
    s_cmp_le_u32 s47, 8
    s_cbranch_scc1 M_G1_110
    v_add_u32_dpp v91, v83, v125 row_newbcast:2 row_mask:0xf bank_mask:0xf
    buffer_load_dwordx4 v[8:11], v91, s[8:11], 0 offen
M_G1_110:
    s_cmp_le_u32 s47, 12
    s_cbranch_scc1 M_G1_111
    v_add_u32_dpp v95, v83, v125 row_newbcast:3 row_mask:0xf bank_mask:0xf
    buffer_load_dwordx4 v[12:15], v95, s[8:11], 0 offen
M_G1_111:
    s_cmp_le_u32 s43, 16
    s_cbranch_scc1 V_NP_112
    v_mul_f32 v76, v76, v19
    v_perm_b32 v34, v20, v16, s41
    v_mul_f32 v77, v77, v23
    v_perm_b32 v38, v20, v16, s42
    v_lshlrev_b32 v19, 16, v19
    v_lshlrev_b32 v23, 16, v23
    v_perm_b32 v42, v21, v17, s41
    v_mul_f32 v72, v72, v19
    v_perm_b32 v46, v21, v17, s42
    v_mul_f32 v73, v73, v23
    v_perm_b32 v50, v22, v18, s41
    v_cvt_pk_bf16_f32 v62, v76, v77
    v_perm_b32 v54, v22, v18, s42
    v_cvt_pk_bf16_f32 v58, v72, v73
V_NP_112:
    s_cmp_le_u32 s47, 16
    s_cbranch_scc1 M_G1_113
    v_add_u32_dpp v91, v83, v125 row_newbcast:4 row_mask:0xf bank_mask:0xf
    buffer_load_dwordx4 v[16:19], v91, s[8:11], 0 offen
M_G1_113:
    s_cmp_le_u32 s47, 20
    s_cbranch_scc1 M_G1_114
    v_add_u32_dpp v95, v83, v125 row_newbcast:5 row_mask:0xf bank_mask:0xf
    buffer_load_dwordx4 v[20:23], v95, s[8:11], 0 offen
M_G1_114:
    s_cmp_le_u32 s43, 24
    s_cbranch_scc1 V_NP_115
    v_mul_f32 v78, v78, v27
    v_perm_b32 v35, v28, v24, s41
    v_mul_f32 v79, v79, v31
    v_perm_b32 v39, v28, v24, s42
    v_lshlrev_b32 v27, 16, v27
    v_lshlrev_b32 v31, 16, v31
    v_perm_b32 v43, v29, v25, s41
    v_mul_f32 v74, v74, v27
    v_perm_b32 v47, v29, v25, s42
    v_mul_f32 v75, v75, v31
    v_perm_b32 v51, v30, v26, s41
    v_cvt_pk_bf16_f32 v63, v78, v79
    v_perm_b32 v55, v30, v26, s42
    v_cvt_pk_bf16_f32 v59, v74, v75
V_NP_115:
    s_cmp_le_u32 s47, 24
    s_cbranch_scc1 M_G1_116
    v_add_u32_dpp v91, v83, v125 row_newbcast:6 row_mask:0xf bank_mask:0xf
    buffer_load_dwordx4 v[24:27], v91, s[8:11], 0 offen
M_G1_116:
    s_cmp_le_u32 s47, 28
    s_cbranch_scc1 M_G1_117
    v_add_u32_dpp v95, v83, v125 row_newbcast:7 row_mask:0xf bank_mask:0xf
    buffer_load_dwordx4 v[28:31], v95, s[8:11], 0 offen
M_G1_117:
    s_bitcmp1_b32 s45, 3
    s_cbranch_scc0 VA_ACC
    v_mfma_f32_16x16x32_bf16 v[80:83], v[112:115], v[56:59], 0
    v_mfma_f32_16x16x32_bf16 v[84:87], v[112:115], v[60:63], 0
VA_ACCB:
    v_mfma_f32_16x16x32_bf16 v[64:67], v[108:111], v[32:35], 0
    v_add_u32_sdwa v91, v117, v124 dst_sel:DWORD dst_unused:UNUSED_PAD src0_sel:WORD_0 src1_sel:DWORD
    v_mfma_f32_16x16x32_bf16 v[68:71], v[108:111], v[36:39], 0
    v_add_u32_sdwa v95, v117, v124 dst_sel:DWORD dst_unused:UNUSED_PAD src0_sel:WORD_1 src1_sel:DWORD
    v_mfma_f32_16x16x32_bf16 v[72:75], v[108:111], v[40:43], 0
    ds_read_b64 v[112:113], v91
    ds_read_b64 v[114:115], v95
    v_mfma_f32_16x16x32_bf16 v[76:79], v[108:111], v[44:47], 0
    v_add_u32_sdwa v91, v116, v123 dst_sel:DWORD dst_unused:UNUSED_PAD src0_sel:WORD_0 src1_sel:DWORD
    v_fmac_f32 v80, v64, v96
    v_fmac_f32 v80, v65, v97
    v_fmac_f32 v80, v66, v98
    v_fmac_f32 v80, v67, v99
    v_mfma_f32_16x16x32_bf16 v[64:67], v[108:111], v[48:51], 0
    v_add_u32_sdwa v95, v116, v123 dst_sel:DWORD dst_unused:UNUSED_PAD src0_sel:WORD_1 src1_sel:DWORD
    v_fmac_f32 v84, v68, v100
    v_fmac_f32 v84, v69, v101
    v_fmac_f32 v84, v70, v102
    v_fmac_f32 v84, v71, v103
    v_mfma_f32_16x16x32_bf16 v[68:71], v[108:111], v[52:55], 0
    ds_read_b64_tr_b16 v[108:109], v91
    ds_read_b64_tr_b16 v[110:111], v95
    s_mul_i32 s5, s46, 272
    v_fmac_f32 v81, v72, v96
    v_fmac_f32 v81, v73, v97
    v_fmac_f32 v81, v74, v98
    v_fmac_f32 v81, v75, v99
    v_fmac_f32 v85, v76, v100
    v_fmac_f32 v85, v77, v101
    v_fmac_f32 v85, v78, v102
    v_fmac_f32 v85, v79, v103
    s_waitcnt lgkmcnt(2)
    s_cmp_le_u32 s47, 16
    s_cbranch_scc1 V_NH_118
    v_mfma_f32_16x16x16_bf16 v[72:75], v[114:115], v[104:105], 0
    v_mfma_f32_16x16x16_bf16 v[76:79], v[114:115], v[106:107], 0
V_NH_118:
    v_lshl_add_u32 v91, v120, 2, s5
    v_fmac_f32 v82, v64, v96
    v_fmac_f32 v82, v65, v97
    v_fmac_f32 v82, v66, v98
    v_fmac_f32 v82, v67, v99
    v_mfma_f32_16x16x16_bf16 v[64:67], v[112:113], v[104:105], 0
    v_fmac_f32 v86, v68, v100
    v_fmac_f32 v86, v69, v101
    v_fmac_f32 v86, v70, v102
    v_fmac_f32 v86, v71, v103
    v_mfma_f32_16x16x16_bf16 v[68:71], v[112:113], v[106:107], 0
    ds_read_b64_tr_b16 v[112:113], v91 offset:18832
    ds_read_b64_tr_b16 v[114:115], v91 offset:18840
    s_cmp_lg_u32 s54, 0
    s_cbranch_scc1 M_ND2_119
    s_bfe_u32 s52, s76, 0x80010
    s_mov_b32 s50, s52
    s_and_b32 s51, s76, 0x7f
    s_lshr_b32 s53, s76, 24
    s_cmp_gt_u32 s51, 32
    s_cselect_b32 s54, s76, 0
    s_cselect_b32 s4, 8, 24
    s_or_b32 s53, s53, s4
    s_min_u32 s51, s51, 32
    s_mov_b32 s76, s77
    s_mov_b32 s77, 0
    s_or_b32 s4, s76, s79
    s_cbranch_scc1 M_NDE_120
    s_mov_b32 s78, 1
    s_mov_b32 exec_lo, 0
    s_mov_b32 exec_hi, 1
    ds_add_rtn_u32 v87, v125, v120 offset:784
    s_mov_b64 exec, -1
    s_branch M_NDE_120
M_ND2_119:
    s_bfe_u32 s50, s54, 0x90007
    s_and_b32 s51, s54, 0x7f
    s_sub_u32 s51, s51, 32
    s_lshr_b32 s53, s54, 24
    s_or_b32 s53, s53, 16
    s_mov_b32 s54, 0
M_NDE_120:
    s_mul_i32 s4, s50, 68
    s_lshl_b32 s5, s4, 2
    v_add_u32 v91, s4, v120
    ds_read_b32 v116, v91 offset:2368
    v_add_u32 v95, s5, v122
    ds_read_u16 v83, v95 offset:18838
    v_add_u32 v91, s4, v121
    ds_read_b32 v117, v91 offset:2368
    s_bitcmp1_b32 s45, 4
    s_mov_b32 s43, s47
    s_mov_b64 s[44:45], s[48:49]
    s_mov_b64 s[46:47], s[50:51]
    s_mov_b64 s[48:49], s[52:53]
    s_cbranch_scc0 VA_TOP0
VB_TOP0:
    s_setprio 2
    s_cmp_eq_u32 s78, 0
    s_cbranch_scc1 M_CT_122
    s_waitcnt lgkmcnt(0)
    s_mov_b32 exec_lo, 0
    s_mov_b32 exec_hi, 1
    ds_read_b32 v91, v87 offset:928
    ds_read_b32 v95, v87 offset:932
    s_mov_b64 exec, -1
M_CT_122:
    s_waitcnt vmcnt(0)
VB_MID:
    s_waitcnt lgkmcnt(0)
    v_lshlrev_b32 v83, 8, v83
    s_cmp_eq_u32 s78, 0
    s_cbranch_scc1 M_CM_123
    v_readlane_b32 s76, v91, 32
    v_readlane_b32 s77, v95, 32
    s_mov_b32 s78, 0
    s_cmp_eq_u32 s76, 0
    s_cselect_b32 s79, 1, 0
M_CM_123:
    s_bitcmp1_b32 s49, 1
    s_cselect_b32 s8, s28, s8
    s_cselect_b32 s9, s29, s9
    v_mul_f32 v68, v68, v3
    v_perm_b32 v32, v4, v0, s41
    v_mul_f32 v69, v69, v7
    v_perm_b32 v36, v4, v0, s42
    v_lshlrev_b32 v3, 16, v3
    v_lshlrev_b32 v7, 16, v7
    v_perm_b32 v40, v5, v1, s41
    v_mul_f32 v64, v64, v3
    v_perm_b32 v44, v5, v1, s42
    v_mul_f32 v65, v65, v7
    v_perm_b32 v48, v6, v2, s41
    v_cvt_pk_bf16_f32 v60, v68, v69
    v_perm_b32 v52, v6, v2, s42
    v_cvt_pk_bf16_f32 v56, v64, v65
V_NP_124:
    s_cmp_le_u32 s47, 0
    s_cbranch_scc1 M_G1_125
    v_add_u32_dpp v91, v83, v125 row_newbcast:0 row_mask:0xf bank_mask:0xf
    buffer_load_dwordx4 v[0:3], v91, s[8:11], 0 offen
M_G1_125:
    s_cmp_le_u32 s47, 4
    s_cbranch_scc1 M_G1_126
    v_add_u32_dpp v95, v83, v125 row_newbcast:1 row_mask:0xf bank_mask:0xf
    buffer_load_dwordx4 v[4:7], v95, s[8:11], 0 offen
M_G1_126:
    s_cmp_le_u32 s43, 8
    s_cbranch_scc1 V_NP_127
    v_mul_f32 v70, v70, v11
    v_perm_b32 v33, v12, v8, s41
    v_mul_f32 v71, v71, v15
    v_perm_b32 v37, v12, v8, s42
    v_lshlrev_b32 v11, 16, v11
    v_lshlrev_b32 v15, 16, v15
    v_perm_b32 v41, v13, v9, s41
    v_mul_f32 v66, v66, v11
    v_perm_b32 v45, v13, v9, s42
    v_mul_f32 v67, v67, v15
    v_perm_b32 v49, v14, v10, s41
    v_cvt_pk_bf16_f32 v61, v70, v71
    v_perm_b32 v53, v14, v10, s42
    v_cvt_pk_bf16_f32 v57, v66, v67
V_NP_127:
    s_cmp_le_u32 s47, 8
    s_cbranch_scc1 M_G1_128
    v_add_u32_dpp v91, v83, v125 row_newbcast:2 row_mask:0xf bank_mask:0xf
    buffer_load_dwordx4 v[8:11], v91, s[8:11], 0 offen
M_G1_128:
    s_cmp_le_u32 s47, 12
    s_cbranch_scc1 M_G1_129
    v_add_u32_dpp v95, v83, v125 row_newbcast:3 row_mask:0xf bank_mask:0xf
    buffer_load_dwordx4 v[12:15], v95, s[8:11], 0 offen
M_G1_129:
    s_cmp_le_u32 s43, 16
    s_cbranch_scc1 V_NP_130
    v_mul_f32 v76, v76, v19
    v_perm_b32 v34, v20, v16, s41
    v_mul_f32 v77, v77, v23
    v_perm_b32 v38, v20, v16, s42
    v_lshlrev_b32 v19, 16, v19
    v_lshlrev_b32 v23, 16, v23
    v_perm_b32 v42, v21, v17, s41
    v_mul_f32 v72, v72, v19
    v_perm_b32 v46, v21, v17, s42
    v_mul_f32 v73, v73, v23
    v_perm_b32 v50, v22, v18, s41
    v_cvt_pk_bf16_f32 v62, v76, v77
    v_perm_b32 v54, v22, v18, s42
    v_cvt_pk_bf16_f32 v58, v72, v73
V_NP_130:
    s_cmp_le_u32 s47, 16
    s_cbranch_scc1 M_G1_131
    v_add_u32_dpp v91, v83, v125 row_newbcast:4 row_mask:0xf bank_mask:0xf
    buffer_load_dwordx4 v[16:19], v91, s[8:11], 0 offen
M_G1_131:
    s_cmp_le_u32 s47, 20
    s_cbranch_scc1 M_G1_132
    v_add_u32_dpp v95, v83, v125 row_newbcast:5 row_mask:0xf bank_mask:0xf
    buffer_load_dwordx4 v[20:23], v95, s[8:11], 0 offen
M_G1_132:
    s_cmp_le_u32 s43, 24
    s_cbranch_scc1 V_NP_133
    v_mul_f32 v78, v78, v27
    v_perm_b32 v35, v28, v24, s41
    v_mul_f32 v79, v79, v31
    v_perm_b32 v39, v28, v24, s42
    v_lshlrev_b32 v27, 16, v27
    v_lshlrev_b32 v31, 16, v31
    v_perm_b32 v43, v29, v25, s41
    v_mul_f32 v74, v74, v27
    v_perm_b32 v47, v29, v25, s42
    v_mul_f32 v75, v75, v31
    v_perm_b32 v51, v30, v26, s41
    v_cvt_pk_bf16_f32 v63, v78, v79
    v_perm_b32 v55, v30, v26, s42
    v_cvt_pk_bf16_f32 v59, v74, v75
V_NP_133:
    s_cmp_le_u32 s47, 24
    s_cbranch_scc1 M_G1_134
    v_add_u32_dpp v91, v83, v125 row_newbcast:6 row_mask:0xf bank_mask:0xf
    buffer_load_dwordx4 v[24:27], v91, s[8:11], 0 offen
M_G1_134:
    s_cmp_le_u32 s47, 28
    s_cbranch_scc1 M_G1_135
    v_add_u32_dpp v95, v83, v125 row_newbcast:7 row_mask:0xf bank_mask:0xf
    buffer_load_dwordx4 v[28:31], v95, s[8:11], 0 offen
M_G1_135:
VB_POST:
    s_bitcmp1_b32 s45, 3
    s_cbranch_scc0 VB_ACC
    v_mfma_f32_16x16x32_bf16 v[88:91], v[112:115], v[56:59], 0
    v_mfma_f32_16x16x32_bf16 v[92:95], v[112:115], v[60:63], 0
VB_ACCB:
    v_mfma_f32_16x16x32_bf16 v[64:67], v[108:111], v[32:35], 0
    v_add_u32_sdwa v83, v117, v124 dst_sel:DWORD dst_unused:UNUSED_PAD src0_sel:WORD_0 src1_sel:DWORD
    v_mfma_f32_16x16x32_bf16 v[68:71], v[108:111], v[36:39], 0
    v_add_u32_sdwa v87, v117, v124 dst_sel:DWORD dst_unused:UNUSED_PAD src0_sel:WORD_1 src1_sel:DWORD
    v_mfma_f32_16x16x32_bf16 v[72:75], v[108:111], v[40:43], 0
    ds_read_b64 v[112:113], v83
    ds_read_b64 v[114:115], v87
    v_mfma_f32_16x16x32_bf16 v[76:79], v[108:111], v[44:47], 0
    v_add_u32_sdwa v83, v116, v123 dst_sel:DWORD dst_unused:UNUSED_PAD src0_sel:WORD_0 src1_sel:DWORD
    v_fmac_f32 v88, v64, v96
    v_fmac_f32 v88, v65, v97
    v_fmac_f32 v88, v66, v98
    v_fmac_f32 v88, v67, v99
    v_mfma_f32_16x16x32_bf16 v[64:67], v[108:111], v[48:51], 0
    v_add_u32_sdwa v87, v116, v123 dst_sel:DWORD dst_unused:UNUSED_PAD src0_sel:WORD_1 src1_sel:DWORD
    v_fmac_f32 v92, v68, v100
    v_fmac_f32 v92, v69, v101
    v_fmac_f32 v92, v70, v102
    v_fmac_f32 v92, v71, v103
    v_mfma_f32_16x16x32_bf16 v[68:71], v[108:111], v[52:55], 0
    ds_read_b64_tr_b16 v[108:109], v83
    ds_read_b64_tr_b16 v[110:111], v87
    s_mul_i32 s5, s46, 272
    v_fmac_f32 v89, v72, v96
    v_fmac_f32 v89, v73, v97
    v_fmac_f32 v89, v74, v98
    v_fmac_f32 v89, v75, v99
    v_fmac_f32 v93, v76, v100
    v_fmac_f32 v93, v77, v101
    v_fmac_f32 v93, v78, v102
    v_fmac_f32 v93, v79, v103
    s_waitcnt lgkmcnt(2)
    s_cmp_le_u32 s47, 16
    s_cbranch_scc1 V_NH_136
    v_mfma_f32_16x16x16_bf16 v[72:75], v[114:115], v[104:105], 0
    v_mfma_f32_16x16x16_bf16 v[76:79], v[114:115], v[106:107], 0
V_NH_136:
    v_lshl_add_u32 v83, v120, 2, s5
    v_fmac_f32 v90, v64, v96
    v_fmac_f32 v90, v65, v97
    v_fmac_f32 v90, v66, v98
    v_fmac_f32 v90, v67, v99
    v_mfma_f32_16x16x16_bf16 v[64:67], v[112:113], v[104:105], 0
    v_fmac_f32 v94, v68, v100
    v_fmac_f32 v94, v69, v101
    v_fmac_f32 v94, v70, v102
    v_fmac_f32 v94, v71, v103
    v_mfma_f32_16x16x16_bf16 v[68:71], v[112:113], v[106:107], 0
    ds_read_b64_tr_b16 v[112:113], v83 offset:18832
    ds_read_b64_tr_b16 v[114:115], v83 offset:18840
    s_cmp_lg_u32 s54, 0
    s_cbranch_scc1 M_ND2_137
    s_bfe_u32 s52, s76, 0x80010
    s_mov_b32 s50, s52
    s_and_b32 s51, s76, 0x7f
    s_lshr_b32 s53, s76, 24
    s_cmp_gt_u32 s51, 32
    s_cselect_b32 s54, s76, 0
    s_cselect_b32 s4, 8, 24
    s_or_b32 s53, s53, s4
    s_min_u32 s51, s51, 32
    s_mov_b32 s76, s77
    s_mov_b32 s77, 0
    s_or_b32 s4, s76, s79
    s_cbranch_scc1 M_NDE_138
    s_mov_b32 s78, 1
    s_mov_b32 exec_lo, 0
    s_mov_b32 exec_hi, 1
    ds_add_rtn_u32 v87, v125, v120 offset:784
    s_mov_b64 exec, -1
    s_branch M_NDE_138
M_ND2_137:
    s_bfe_u32 s50, s54, 0x90007
    s_and_b32 s51, s54, 0x7f
    s_sub_u32 s51, s51, 32
    s_lshr_b32 s53, s54, 24
    s_or_b32 s53, s53, 16
    s_mov_b32 s54, 0
M_NDE_138:
    s_mul_i32 s4, s50, 68
    s_lshl_b32 s5, s4, 2
    v_add_u32 v91, s4, v120
    ds_read_b32 v116, v91 offset:2368
    v_add_u32 v95, s5, v122
    ds_read_u16 v83, v95 offset:18838
    v_add_u32 v91, s4, v121
    ds_read_b32 v117, v91 offset:2368
    s_bitcmp1_b32 s45, 4
    s_cbranch_scc1 V_EPI
    s_mov_b32 s43, s47
    s_mov_b64 s[44:45], s[48:49]
    s_mov_b64 s[46:47], s[50:51]
    s_mov_b64 s[48:49], s[52:53]
    s_branch VB_TOP0
V_EPI:
    s_bitcmp1_b32 s45, 0
    s_cbranch_scc0 V_SKIP
    s_mul_i32 s5, s44, 192
    v_add_u32 v32, s5, v126
    v_add_u32 v36, s5, v127
    ds_read_b32 v91, v32
    ds_read_u16_d16_hi v95, v36
    v_permlane32_swap_b32 v80, v88
    v_permlane32_swap_b32 v81, v89
    v_permlane32_swap_b32 v82, v90
    v_permlane32_swap_b32 v84, v92
    v_permlane32_swap_b32 v85, v93
    v_permlane32_swap_b32 v86, v94
    v_add_f32 v80, v80, v88
    v_add_f32 v84, v84, v92
    v_add_f32 v81, v81, v89
    v_add_f32 v85, v85, v93
    v_add_f32 v82, v82, v90
    v_add_f32 v86, v86, v94
    v_permlane16_swap_b32 v80, v81
    v_permlane16_swap_b32 v84, v85
    v_permlane16_swap_b32 v82, v86
    v_add_f32 v80, v80, v81
    v_add_f32 v84, v84, v85
    v_add_f32 v82, v82, v86
    s_cmp_lg_u32 s55, 0
    s_cbranch_scc1 V_SLOW
V_BACK:
    s_waitcnt lgkmcnt(0)
    v_lshlrev_b32 v88, 16, v91
    v_and_b32 v89, 0xffff0000, v91
    v_add_f32 v82, v82, v95
    v_add_f32 v80, v80, v88
    v_add_f32 v84, v84, v89
    v_cvt_pk_bf16_f32 v82, v82, v82
    v_cvt_pk_bf16_f32 v80, v80, v84
    ds_write_b16 v36, v82
    ds_write_b32 v32, v80
    s_branch V_SKIP
V_SLOW:
    v_mbcnt_lo_u32_b32 v88, -1, 0
    v_mbcnt_hi_u32_b32 v88, -1, v88
    v_lshlrev_b32 v88, 2, v88
    s_mul_i32 s6, s2, 200704
    s_lshl_b32 s7, s44, 9
    s_add_u32 s6, s6, s7
    s_add_u32 s6, s6, 27262464
    s_cmp_lg_u32 s38, 0
    s_cbranch_scc1 M_NOC_140
    buffer_load_dword v89, v88, s[20:23], s6 offen offset:0 sc1
    s_waitcnt vmcnt(0)
    v_add_f32 v80, v80, v89
    buffer_load_dword v89, v88, s[20:23], s6 offen offset:256 sc1
    s_waitcnt vmcnt(0)
    v_add_f32 v84, v84, v89
    buffer_load_dword v89, v88, s[20:23], s6 offen offset:512 sc1
    s_waitcnt vmcnt(0)
    v_add_f32 v82, v82, v89
M_NOC_140:
    s_cmp_eq_u32 s39, 0
    s_cbranch_scc1 V_BACK
    buffer_store_dword v80, v88, s[20:23], s6 offen offset:0 sc1
    buffer_store_dword v84, v88, s[20:23], s6 offen offset:256 sc1
    buffer_store_dword v82, v88, s[20:23], s6 offen offset:512 sc1
V_SKIP:
    s_mov_b32 s43, s47
    s_mov_b64 s[44:45], s[48:49]
    s_mov_b64 s[46:47], s[50:51]
    s_mov_b64 s[48:49], s[52:53]
    s_and_b32 s4, s45, 6
    s_cmp_eq_u32 s4, 4
    s_cbranch_scc1 VA_TOP0
    s_branch S_START
VA_ACC:
    v_mfma_f32_16x16x32_bf16 v[80:83], v[112:115], v[56:59], v[80:83]
    v_mfma_f32_16x16x32_bf16 v[84:87], v[112:115], v[60:63], v[84:87]
    s_branch VA_ACCB
VB_ACC:
    v_mfma_f32_16x16x32_bf16 v[88:91], v[112:115], v[56:59], v[88:91]
    v_mfma_f32_16x16x32_bf16 v[92:95], v[112:115], v[60:63], v[92:95]
    s_branch VB_ACCB
S_START:
    s_setprio 0
    v_mov_b32 v32, 2352
    v_mov_b32 v33, 1
    s_mov_b64 exec, 1
    ds_add_u32 v32, v33
    s_mov_b64 exec, -1
    s_bitcmp1_b32 s45, 2
    s_cbranch_scc0 M_DONE
    v_mbcnt_lo_u32_b32 v127, -1, 0
    v_mbcnt_hi_u32_b32 v127, -1, v127
    v_lshrrev_b32 v127, 4, v127
    v_lshl_add_u32 v126, v127, 2, v125
    v_subrev_u32 v127, 5952, v119
    ds_read_b128 v[32:35], v127 offset:0
    ds_read_b128 v[36:39], v127 offset:1024
    ds_read_b128 v[40:43], v127 offset:2048
    ds_read_b128 v[44:47], v127 offset:3072
    s_add_u32 s6, s35, s44
    s_min_u32 s6, s6, 12499
    s_lshl_b32 s6, s6, 10
    buffer_load_dword v118, v126, s[12:15], s6 offen
    s_waitcnt lgkmcnt(0)
    v_lshlrev_b32 v64, 16, v32
    v_and_b32 v68, 0xffff0000, v32
    v_lshlrev_b32 v72, 16, v33
    v_and_b32 v76, 0xffff0000, v33
    v_lshlrev_b32 v80, 16, v34
    v_and_b32 v85, 0xffff0000, v34
    v_lshlrev_b32 v90, 16, v35
    v_and_b32 v96, 0xffff0000, v35
    v_lshlrev_b32 v65, 16, v36
    v_and_b32 v69, 0xffff0000, v36
    v_lshlrev_b32 v73, 16, v37
    v_and_b32 v77, 0xffff0000, v37
    v_lshlrev_b32 v81, 16, v38
    v_and_b32 v86, 0xffff0000, v38
    v_lshlrev_b32 v92, 16, v39
    v_and_b32 v97, 0xffff0000, v39
    v_lshlrev_b32 v66, 16, v40
    v_and_b32 v70, 0xffff0000, v40
    v_lshlrev_b32 v74, 16, v41
    v_and_b32 v78, 0xffff0000, v41
    v_lshlrev_b32 v82, 16, v42
    v_and_b32 v88, 0xffff0000, v42
    v_lshlrev_b32 v93, 16, v43
    v_and_b32 v98, 0xffff0000, v43
    v_lshlrev_b32 v67, 16, v44
    v_and_b32 v71, 0xffff0000, v44
    v_lshlrev_b32 v75, 16, v45
    v_and_b32 v79, 0xffff0000, v45
    v_lshlrev_b32 v84, 16, v46
    v_and_b32 v89, 0xffff0000, v46
    v_lshlrev_b32 v94, 16, v47
    v_and_b32 v99, 0xffff0000, v47
S_TOP0:
    s_waitcnt vmcnt(0)
S_TOP:
    s_cmp_eq_u32 s78, 0
    s_cbranch_scc1 M_CT_141
    s_waitcnt lgkmcnt(0)
    s_mov_b32 exec_lo, 0
    s_mov_b32 exec_hi, 1
    ds_read_b32 v91, v87 offset:928
    ds_read_b32 v95, v87 offset:932
    s_mov_b64 exec, -1
M_CT_141:
    s_waitcnt vmcnt(1) lgkmcnt(0)
    v_lshlrev_b32 v83, 8, v83
    v_mov_b32 v119, v118
    s_cmp_eq_u32 s78, 0
    s_cbranch_scc1 M_CM_142
    v_readlane_b32 s76, v91, 32
    v_readlane_b32 s77, v95, 32
    s_mov_b32 s78, 0
    s_cmp_eq_u32 s76, 0
    s_cselect_b32 s79, 1, 0
M_CM_142:
    s_bitcmp1_b32 s49, 3
    s_cbranch_scc0 S_NSV_143
    s_add_u32 s6, s35, s48
    s_min_u32 s6, s6, 12499
    s_lshl_b32 s6, s6, 10
    buffer_load_dword v118, v126, s[12:15], s6 offen
S_NSV_143:
    v_perm_b32 v32, v4, v0, s41
    v_perm_b32 v36, v4, v0, s42
    v_perm_b32 v40, v5, v1, s41
    v_perm_b32 v44, v5, v1, s42
    v_perm_b32 v48, v6, v2, s41
    v_perm_b32 v52, v6, v2, s42
    v_perm_b32 v56, v7, v3, s41
    v_perm_b32 v60, v7, v3, s42
    s_cmp_le_u32 s47, 0
    s_cbranch_scc1 M_G1_144
    v_add_u32_dpp v91, v83, v125 row_newbcast:0 row_mask:0xf bank_mask:0xf
    buffer_load_dwordx4 v[0:3], v91, s[8:11], 0 offen
M_G1_144:
    s_cmp_le_u32 s47, 4
    s_cbranch_scc1 M_G1_145
    v_add_u32_dpp v95, v83, v125 row_newbcast:1 row_mask:0xf bank_mask:0xf
    buffer_load_dwordx4 v[4:7], v95, s[8:11], 0 offen
M_G1_145:
    v_perm_b32 v33, v12, v8, s41
    v_perm_b32 v37, v12, v8, s42
    v_perm_b32 v41, v13, v9, s41
    v_perm_b32 v45, v13, v9, s42
    v_perm_b32 v49, v14, v10, s41
    v_perm_b32 v53, v14, v10, s42
    v_perm_b32 v57, v15, v11, s41
    v_perm_b32 v61, v15, v11, s42
    s_cmp_le_u32 s47, 8
    s_cbranch_scc1 M_G1_146
    v_add_u32_dpp v91, v83, v125 row_newbcast:2 row_mask:0xf bank_mask:0xf
    buffer_load_dwordx4 v[8:11], v91, s[8:11], 0 offen
M_G1_146:
    s_cmp_le_u32 s47, 12
    s_cbranch_scc1 M_G1_147
    v_add_u32_dpp v95, v83, v125 row_newbcast:3 row_mask:0xf bank_mask:0xf
    buffer_load_dwordx4 v[12:15], v95, s[8:11], 0 offen
M_G1_147:
    v_perm_b32 v34, v20, v16, s41
    v_perm_b32 v38, v20, v16, s42
    v_perm_b32 v42, v21, v17, s41
    v_perm_b32 v46, v21, v17, s42
    v_perm_b32 v50, v22, v18, s41
    v_perm_b32 v54, v22, v18, s42
    v_perm_b32 v58, v23, v19, s41
    v_perm_b32 v62, v23, v19, s42
    s_cmp_le_u32 s47, 16
    s_cbranch_scc1 M_G1_148
    v_add_u32_dpp v91, v83, v125 row_newbcast:4 row_mask:0xf bank_mask:0xf
    buffer_load_dwordx4 v[16:19], v91, s[8:11], 0 offen
M_G1_148:
    s_cmp_le_u32 s47, 20
    s_cbranch_scc1 M_G1_149
    v_add_u32_dpp v95, v83, v125 row_newbcast:5 row_mask:0xf bank_mask:0xf
    buffer_load_dwordx4 v[20:23], v95, s[8:11], 0 offen
M_G1_149:
    v_perm_b32 v35, v28, v24, s41
    v_perm_b32 v39, v28, v24, s42
    v_perm_b32 v43, v29, v25, s41
    v_perm_b32 v47, v29, v25, s42
    v_perm_b32 v51, v30, v26, s41
    v_perm_b32 v55, v30, v26, s42
    v_perm_b32 v59, v31, v27, s41
    v_perm_b32 v63, v31, v27, s42
    s_cmp_le_u32 s47, 24
    s_cbranch_scc1 M_G1_150
    v_add_u32_dpp v91, v83, v125 row_newbcast:6 row_mask:0xf bank_mask:0xf
    buffer_load_dwordx4 v[24:27], v91, s[8:11], 0 offen
M_G1_150:
    s_cmp_le_u32 s47, 28
    s_cbranch_scc1 M_G1_151
    v_add_u32_dpp v95, v83, v125 row_newbcast:7 row_mask:0xf bank_mask:0xf
    buffer_load_dwordx4 v[28:31], v95, s[8:11], 0 offen
M_G1_151:
    v_mfma_f32_16x16x32_bf16 v[32:35], v[108:111], v[32:35], 0
    v_mfma_f32_16x16x32_bf16 v[36:39], v[108:111], v[36:39], 0
    v_mfma_f32_16x16x32_bf16 v[40:43], v[108:111], v[40:43], 0
    v_add_u32_sdwa v91, v116, v123 dst_sel:DWORD dst_unused:UNUSED_PAD src0_sel:WORD_0 src1_sel:DWORD
    v_mfma_f32_16x16x32_bf16 v[44:47], v[108:111], v[44:47], 0
    v_mfma_f32_16x16x32_bf16 v[48:51], v[108:111], v[48:51], 0
    v_add_u32_sdwa v95, v116, v123 dst_sel:DWORD dst_unused:UNUSED_PAD src0_sel:WORD_1 src1_sel:DWORD
    v_mfma_f32_16x16x32_bf16 v[52:55], v[108:111], v[52:55], 0
    v_mfma_f32_16x16x32_bf16 v[56:59], v[108:111], v[56:59], 0
    v_mfma_f32_16x16x32_bf16 v[60:63], v[108:111], v[60:63], 0
    ds_read_b64_tr_b16 v[108:109], v91
    ds_read_b64_tr_b16 v[110:111], v95
    s_cmp_lg_u32 s54, 0
    s_cbranch_scc1 M_ND2_152
    s_bfe_u32 s52, s76, 0x80010
    s_mov_b32 s50, s52
    s_and_b32 s51, s76, 0x7f
    s_lshr_b32 s53, s76, 24
    s_cmp_gt_u32 s51, 32
    s_cselect_b32 s54, s76, 0
    s_cselect_b32 s4, 8, 24
    s_or_b32 s53, s53, s4
    s_min_u32 s51, s51, 32
    s_mov_b32 s76, s77
    s_mov_b32 s77, 0
    s_or_b32 s4, s76, s79
    s_cbranch_scc1 M_NDE_153
    s_mov_b32 s78, 1
    s_mov_b32 exec_lo, 0
    s_mov_b32 exec_hi, 1
    ds_add_rtn_u32 v87, v125, v120 offset:784
    s_mov_b64 exec, -1
    s_branch M_NDE_153
M_ND2_152:
    s_bfe_u32 s50, s54, 0x90007
    s_and_b32 s51, s54, 0x7f
    s_sub_u32 s51, s51, 32
    s_lshr_b32 s53, s54, 24
    s_or_b32 s53, s53, 16
    s_mov_b32 s54, 0
M_NDE_153:
    s_mul_i32 s4, s50, 68
    s_lshl_b32 s5, s4, 2
    v_add_u32 v91, s4, v120
    ds_read_b32 v116, v91 offset:2368
    v_add_u32 v95, s5, v122
    ds_read_u16 v83, v95 offset:18838
    v_mul_f32 v32, v32, v64
    v_fmac_f32 v32, v33, v65
    v_fmac_f32 v32, v34, v66
    v_fmac_f32 v32, v35, v67
    v_mul_f32 v36, v36, v68
    v_fmac_f32 v36, v37, v69
    v_fmac_f32 v36, v38, v70
    v_fmac_f32 v36, v39, v71
    v_mul_f32 v40, v40, v72
    v_fmac_f32 v40, v41, v73
    v_fmac_f32 v40, v42, v74
    v_fmac_f32 v40, v43, v75
    v_mul_f32 v44, v44, v76
    v_fmac_f32 v44, v45, v77
    v_fmac_f32 v44, v46, v78
    v_fmac_f32 v44, v47, v79
    v_mul_f32 v48, v48, v80
    v_fmac_f32 v48, v49, v81
    v_fmac_f32 v48, v50, v82
    v_fmac_f32 v48, v51, v84
    v_mul_f32 v52, v52, v85
    v_fmac_f32 v52, v53, v86
    v_fmac_f32 v52, v54, v88
    v_fmac_f32 v52, v55, v89
    v_mul_f32 v56, v56, v90
    v_fmac_f32 v56, v57, v92
    v_fmac_f32 v56, v58, v93
    v_fmac_f32 v56, v59, v94
    v_mul_f32 v60, v60, v96
    v_fmac_f32 v60, v61, v97
    v_fmac_f32 v60, v62, v98
    v_fmac_f32 v60, v63, v99
    s_bitcmp1_b32 s45, 3
    s_cbranch_scc1 S_NOCAR
    v_add_f32 v32, v32, v100
    v_add_f32 v36, v36, v101
    v_add_f32 v40, v40, v102
    v_add_f32 v44, v44, v103
    v_add_f32 v48, v48, v104
    v_add_f32 v52, v52, v105
    v_add_f32 v56, v56, v106
    v_add_f32 v60, v60, v107
S_NOCAR:
    s_and_b32 s4, s45, 17
    s_cmp_eq_u32 s4, 17
    s_cbranch_scc1 S_EPI
    v_mov_b32 v100, v32
    v_mov_b32 v101, v36
    v_mov_b32 v102, v40
    v_mov_b32 v103, v44
    v_mov_b32 v104, v48
    v_mov_b32 v105, v52
    v_mov_b32 v106, v56
    v_mov_b32 v107, v60
S_SKIP:
    s_mov_b32 s43, s47
    s_mov_b64 s[44:45], s[48:49]
    s_mov_b64 s[46:47], s[50:51]
    s_mov_b64 s[48:49], s[52:53]
    s_bitcmp1_b32 s45, 2
    s_cbranch_scc1 S_TOP0
    s_branch M_DONE
S_EPI:
    v_permlane32_swap_b32 v32, v48
    v_permlane32_swap_b32 v36, v52
    v_permlane32_swap_b32 v40, v56
    v_permlane32_swap_b32 v44, v60
    v_add_f32 v32, v32, v48
    v_add_f32 v36, v36, v52
    v_add_f32 v40, v40, v56
    v_add_f32 v44, v44, v60
    s_nop 0
    v_permlane16_swap_b32 v32, v40
    v_permlane16_swap_b32 v36, v44
    v_add_f32 v32, v32, v40
    v_add_f32 v36, v36, v44
    s_cmp_lg_u32 s55, 0
    s_cbranch_scc1 S_SLOW
S_BACK:
    v_lshlrev_b32 v40, 16, v119
    v_and_b32 v44, 0xffff0000, v119
    v_add_f32 v32, v32, v40
    v_add_f32 v36, v36, v44
    s_add_u32 s6, s35, s44
    s_lshl_b32 s6, s6, 10
    v_cvt_pk_bf16_f32 v32, v32, v36
    buffer_store_dword v32, v126, s[16:19], s6 offen sc1
    s_mov_b32 s43, s47
    s_mov_b64 s[44:45], s[48:49]
    s_mov_b64 s[46:47], s[50:51]
    s_mov_b64 s[48:49], s[52:53]
    s_bitcmp1_b32 s45, 2
    s_cbranch_scc1 S_TOP
    s_branch M_DONE
S_SLOW:
    v_mbcnt_lo_u32_b32 v91, -1, 0
    v_mbcnt_hi_u32_b32 v91, -1, v91
    v_lshlrev_b32 v91, 2, v91
    s_mul_i32 s6, s2, 200704
    s_lshl_b32 s7, s44, 9
    s_add_u32 s6, s6, s7
    s_add_u32 s6, s6, 27363328
    s_cmp_lg_u32 s38, 0
    s_cbranch_scc1 M_NOC_155
    buffer_load_dword v95, v91, s[20:23], s6 offen offset:0 sc1
    s_waitcnt vmcnt(0)
    v_add_f32 v32, v32, v95
    buffer_load_dword v95, v91, s[20:23], s6 offen offset:256 sc1
    s_waitcnt vmcnt(0)
    v_add_f32 v36, v36, v95
M_NOC_155:
    s_cmp_eq_u32 s39, 0
    s_cbranch_scc1 S_BACK
    buffer_store_dword v32, v91, s[20:23], s6 offen offset:0 sc1
    buffer_store_dword v36, v91, s[20:23], s6 offen offset:256 sc1
    s_branch S_SKIP
M_DONE:
    s_cmp_lg_u32 s39, 0
    s_cbranch_scc1 M_NOFL
    v_mov_b32 v32, 2352
    v_mov_b32 v33, 1
    v_mbcnt_lo_u32_b32 v34, -1, 0
    v_mbcnt_hi_u32_b32 v34, -1, v34
    v_lshrrev_b32 v35, 2, v34
    v_and_b32 v36, 3, v34
    s_lshl_b32 s3, s35, 10
    s_lshl_b32 s4, s33, 6
    s_add_u32 s3, s3, s4
    s_add_u32 s3, s3, 256
    v_lshl_add_u32 v36, v36, 4, s3
    v_lshlrev_b32 v34, 4, v34
    v_add_u32 v34, 91136, v34
M_FW:
    ds_read_b32 v37, v32
    s_waitcnt lgkmcnt(0)
    v_readfirstlane_b32 s3, v37
    s_cmp_lt_u32 s3, 16
    s_cbranch_scc1 M_FW
M_FL:
    s_mov_b64 exec, 1
    ds_add_rtn_u32 v37, v32, v33 offset:4
    s_mov_b64 exec, -1
    s_waitcnt lgkmcnt(0)
    v_readfirstlane_b32 s3, v37
    s_cmp_ge_u32 s3, 37
    s_cbranch_scc1 M_NOFL
    s_lshl_b32 s4, s3, 10
    v_add_u32 v38, s4, v34
    ds_read_b128 v[40:43], v38
    s_lshl_b32 s4, s3, 4
    v_add_u32 v38, s4, v35
    v_mul_u32_u24 v39, 21846, v38
    v_cmp_gt_u32 vcc, 588, v38
    v_lshrrev_b32 v39, 16, v39
    v_add_u32 v39, v39, v38
    v_lshl_add_u32 v39, v39, 8, v36
    s_mov_b64 exec, vcc
    s_waitcnt lgkmcnt(0)
    buffer_store_dwordx4 v[40:43], v39, s[16:19], 0 offen sc1
    s_branch M_FL
M_NOFL:
    s_cmp_eq_u32 s39, 0
    s_cbranch_scc1 M_END
    s_waitcnt vmcnt(0) lgkmcnt(0)
    s_barrier
    s_mov_b32 s38, 0
    s_mov_b32 s37, 0
    s_bitcmp1_b32 s39, 0
    s_cbranch_scc1 M_ROUND
    s_xor_b32 s84, s84, 1
    s_bitcmp1_b32 s39, 2
    s_cbranch_scc1 M_ROUND
    s_mov_b32 s84, 0
    s_mov_b32 s37, 1
    s_add_u32 s36, s36, 80
    s_branch M_ROUND
M_RARE_32:
    s_mov_b64 s[0:1], vcc
    s_andn2_b64 exec, exec, vcc
    v_mov_b32 v2, 2360
    v_mov_b32 v3, 32
    ds_add_rtn_u32 v4, v2, v3
    s_xor_b32 s3, s84, 1
    s_mul_i32 s3, s3, 33792
    s_add_u32 s3, s3, 20975616
    s_waitcnt lgkmcnt(0)
    v_cmp_gt_u32 vcc, 1024, v4
    s_and_b64 exec, exec, vcc
    s_cbranch_execz M_RAREX_156
    buffer_load_dwordx4 v[8:11], v34, s[20:23], s3 offen
    buffer_load_dwordx4 v[12:15], v34, s[20:23], s3 offen offset:16
    v_add_u32 v5, 162816, v4
    v_add_u32 v34, 33792, v4
    s_waitcnt vmcnt(0)
    ds_write_b128 v5, v[8:11]
    ds_write_b128 v5, v[12:15] offset:16
M_RAREX_156:
    s_or_b64 exec, exec, s[0:1]
    s_branch M_RAREB_33
M_RARE_35:
    s_mov_b64 s[0:1], vcc
    s_andn2_b64 exec, exec, vcc
    v_mov_b32 v2, 2360
    v_mov_b32 v3, 32
    ds_add_rtn_u32 v4, v2, v3
    s_xor_b32 s3, s84, 1
    s_mul_i32 s3, s3, 33792
    s_add_u32 s3, s3, 20975616
    s_waitcnt lgkmcnt(0)
    v_cmp_gt_u32 vcc, 1024, v4
    s_and_b64 exec, exec, vcc
    s_cbranch_execz M_RAREX_157
    buffer_load_dwordx4 v[8:11], v38, s[20:23], s3 offen
    buffer_load_dwordx4 v[12:15], v38, s[20:23], s3 offen offset:16
    v_add_u32 v5, 162816, v4
    v_add_u32 v38, 33792, v4
    s_waitcnt vmcnt(0)
    ds_write_b128 v5, v[8:11]
    ds_write_b128 v5, v[12:15] offset:16
M_RAREX_157:
    s_or_b64 exec, exec, s[0:1]
    s_branch M_RAREB_36
M_RARE_38:
    s_mov_b64 s[0:1], vcc
    s_andn2_b64 exec, exec, vcc
    v_mov_b32 v2, 2360
    v_mov_b32 v3, 32
    ds_add_rtn_u32 v4, v2, v3
    s_xor_b32 s3, s84, 1
    s_mul_i32 s3, s3, 33792
    s_add_u32 s3, s3, 20975616
    s_waitcnt lgkmcnt(0)
    v_cmp_gt_u32 vcc, 1024, v4
    s_and_b64 exec, exec, vcc
    s_cbranch_execz M_RAREX_158
    buffer_load_dwordx4 v[8:11], v42, s[20:23], s3 offen
    buffer_load_dwordx4 v[12:15], v42, s[20:23], s3 offen offset:16
    v_add_u32 v5, 162816, v4
    v_add_u32 v42, 33792, v4
    s_waitcnt vmcnt(0)
    ds_write_b128 v5, v[8:11]
    ds_write_b128 v5, v[12:15] offset:16
M_RAREX_158:
    s_or_b64 exec, exec, s[0:1]
    s_branch M_RAREB_39
M_RARE_41:
    s_mov_b64 s[0:1], vcc
    s_andn2_b64 exec, exec, vcc
    v_mov_b32 v2, 2360
    v_mov_b32 v3, 32
    ds_add_rtn_u32 v4, v2, v3
    s_xor_b32 s3, s84, 1
    s_mul_i32 s3, s3, 33792
    s_add_u32 s3, s3, 20975616
    s_waitcnt lgkmcnt(0)
    v_cmp_gt_u32 vcc, 1024, v4
    s_and_b64 exec, exec, vcc
    s_cbranch_execz M_RAREX_159
    buffer_load_dwordx4 v[8:11], v46, s[20:23], s3 offen
    buffer_load_dwordx4 v[12:15], v46, s[20:23], s3 offen offset:16
    v_add_u32 v5, 162816, v4
    v_add_u32 v46, 33792, v4
    s_waitcnt vmcnt(0)
    ds_write_b128 v5, v[8:11]
    ds_write_b128 v5, v[12:15] offset:16
M_RAREX_159:
    s_or_b64 exec, exec, s[0:1]
    s_branch M_RAREB_42
M_RARE_44:
    s_mov_b64 s[0:1], vcc
    s_andn2_b64 exec, exec, vcc
    v_mov_b32 v2, 2360
    v_mov_b32 v3, 32
    ds_add_rtn_u32 v4, v2, v3
    s_xor_b32 s3, s84, 1
    s_mul_i32 s3, s3, 33792
    s_add_u32 s3, s3, 20975616
    s_waitcnt lgkmcnt(0)
    v_cmp_gt_u32 vcc, 1024, v4
    s_and_b64 exec, exec, vcc
    s_cbranch_execz M_RAREX_160
    buffer_load_dwordx4 v[8:11], v50, s[20:23], s3 offen
    buffer_load_dwordx4 v[12:15], v50, s[20:23], s3 offen offset:16
    v_add_u32 v5, 162816, v4
    v_add_u32 v50, 33792, v4
    s_waitcnt vmcnt(0)
    ds_write_b128 v5, v[8:11]
    ds_write_b128 v5, v[12:15] offset:16
M_RAREX_160:
    s_or_b64 exec, exec, s[0:1]
    s_branch M_RAREB_45
M_RARE_47:
    s_mov_b64 s[0:1], vcc
    s_andn2_b64 exec, exec, vcc
    v_mov_b32 v2, 2360
    v_mov_b32 v3, 32
    ds_add_rtn_u32 v4, v2, v3
    s_xor_b32 s3, s84, 1
    s_mul_i32 s3, s3, 33792
    s_add_u32 s3, s3, 20975616
    s_waitcnt lgkmcnt(0)
    v_cmp_gt_u32 vcc, 1024, v4
    s_and_b64 exec, exec, vcc
    s_cbranch_execz M_RAREX_161
    buffer_load_dwordx4 v[8:11], v54, s[20:23], s3 offen
    buffer_load_dwordx4 v[12:15], v54, s[20:23], s3 offen offset:16
    v_add_u32 v5, 162816, v4
    v_add_u32 v54, 33792, v4
    s_waitcnt vmcnt(0)
    ds_write_b128 v5, v[8:11]
    ds_write_b128 v5, v[12:15] offset:16
M_RAREX_161:
    s_or_b64 exec, exec, s[0:1]
    s_branch M_RAREB_48
M_RARE_50:
    s_mov_b64 s[0:1], vcc
    s_andn2_b64 exec, exec, vcc
    v_mov_b32 v2, 2360
    v_mov_b32 v3, 32
    ds_add_rtn_u32 v4, v2, v3
    s_xor_b32 s3, s84, 1
    s_mul_i32 s3, s3, 33792
    s_add_u32 s3, s3, 20975616
    s_waitcnt lgkmcnt(0)
    v_cmp_gt_u32 vcc, 1024, v4
    s_and_b64 exec, exec, vcc
    s_cbranch_execz M_RAREX_162
    buffer_load_dwordx4 v[8:11], v58, s[20:23], s3 offen
    buffer_load_dwordx4 v[12:15], v58, s[20:23], s3 offen offset:16
    v_add_u32 v5, 162816, v4
    v_add_u32 v58, 33792, v4
    s_waitcnt vmcnt(0)
    ds_write_b128 v5, v[8:11]
    ds_write_b128 v5, v[12:15] offset:16
M_RAREX_162:
    s_or_b64 exec, exec, s[0:1]
    s_branch M_RAREB_51
M_RARE_53:
    s_mov_b64 s[0:1], vcc
    s_andn2_b64 exec, exec, vcc
    v_mov_b32 v2, 2360
    v_mov_b32 v3, 32
    ds_add_rtn_u32 v4, v2, v3
    s_xor_b32 s3, s84, 1
    s_mul_i32 s3, s3, 33792
    s_add_u32 s3, s3, 20975616
    s_waitcnt lgkmcnt(0)
    v_cmp_gt_u32 vcc, 1024, v4
    s_and_b64 exec, exec, vcc
    s_cbranch_execz M_RAREX_163
    buffer_load_dwordx4 v[8:11], v62, s[20:23], s3 offen
    buffer_load_dwordx4 v[12:15], v62, s[20:23], s3 offen offset:16
    v_add_u32 v5, 162816, v4
    v_add_u32 v62, 33792, v4
    s_waitcnt vmcnt(0)
    ds_write_b128 v5, v[8:11]
    ds_write_b128 v5, v[12:15] offset:16
M_RAREX_163:
    s_or_b64 exec, exec, s[0:1]
    s_branch M_RAREB_54
M_RARE_56:
    s_mov_b64 s[0:1], vcc
    s_andn2_b64 exec, exec, vcc
    v_mov_b32 v2, 2360
    v_mov_b32 v3, 32
    ds_add_rtn_u32 v4, v2, v3
    s_xor_b32 s3, s84, 1
    s_mul_i32 s3, s3, 33792
    s_add_u32 s3, s3, 20975616
    s_waitcnt lgkmcnt(0)
    v_cmp_gt_u32 vcc, 1024, v4
    s_and_b64 exec, exec, vcc
    s_cbranch_execz M_RAREX_164
    buffer_load_dwordx4 v[8:11], v66, s[20:23], s3 offen
    buffer_load_dwordx4 v[12:15], v66, s[20:23], s3 offen offset:16
    v_add_u32 v5, 162816, v4
    v_add_u32 v66, 33792, v4
    s_waitcnt vmcnt(0)
    ds_write_b128 v5, v[8:11]
    ds_write_b128 v5, v[12:15] offset:16
M_RAREX_164:
    s_or_b64 exec, exec, s[0:1]
    s_branch M_RAREB_57
M_RARE_59:
    s_mov_b64 s[0:1], vcc
    s_andn2_b64 exec, exec, vcc
    v_mov_b32 v2, 2360
    v_mov_b32 v3, 32
    ds_add_rtn_u32 v4, v2, v3
    s_xor_b32 s3, s84, 1
    s_mul_i32 s3, s3, 33792
    s_add_u32 s3, s3, 20975616
    s_waitcnt lgkmcnt(0)
    v_cmp_gt_u32 vcc, 1024, v4
    s_and_b64 exec, exec, vcc
    s_cbranch_execz M_RAREX_165
    buffer_load_dwordx4 v[8:11], v70, s[20:23], s3 offen
    buffer_load_dwordx4 v[12:15], v70, s[20:23], s3 offen offset:16
    v_add_u32 v5, 162816, v4
    v_add_u32 v70, 33792, v4
    s_waitcnt vmcnt(0)
    ds_write_b128 v5, v[8:11]
    ds_write_b128 v5, v[12:15] offset:16
M_RAREX_165:
    s_or_b64 exec, exec, s[0:1]
    s_branch M_RAREB_60
M_END:
    s_endpgm
.section .rodata,"a"
.p2align 6
.amdhsa_kernel standalone__molecular_angular_painn__graph_kernel
  .amdhsa_next_free_vgpr 128
  .amdhsa_next_free_sgpr 102
  .amdhsa_accum_offset 128
  .amdhsa_group_segment_fixed_size 0
  .amdhsa_kernarg_size 88
  .amdhsa_user_sgpr_count 2
  .amdhsa_user_sgpr_kernarg_segment_ptr 1
  .amdhsa_system_sgpr_workgroup_id_x 1
  .amdhsa_float_denorm_mode_32 3
.end_amdhsa_kernel
```
